```python
import torch

def _softmax(x, axis=-1):
    return torch.softmax(x, dim=axis)
def _gelu(x):
    return torch.nn.functional.gelu(x, approximate="tanh")
def _silu(x):
    return torch.nn.functional.silu(x)
def _sigmoid(x):
    return torch.sigmoid(x)
def _layernorm(x, axis=-1, eps=1e-5):
    m = x.mean(dim=axis, keepdim=True)
    v = x.var(dim=axis, keepdim=True, unbiased=False)
    return (x - m) / torch.sqrt(v + eps)
def _scatter_add(tgt, idx, src, axis=0):
    return tgt.clone().index_add_(axis, idx, src)
def _segment_sum(src, seg, n):
    out = torch.zeros((n,) + src.shape[1:], dtype=src.dtype)
    return out.index_add_(0, seg, src)
def _pad(x, pw):
    flat = tuple(v for pair in reversed(pw) for v in pair)
    return torch.nn.functional.pad(x, flat)

kernel_name = 'gated_mix__mha_block_cached__gqa_block_cached__decode'

def setup_inputs():

    _w = (lambda a: (lambda t: t.to(torch.bfloat16) if t.is_floating_point() else t)(torch.as_tensor(a)))
    def _A_setup():
        B, Sq, D = 8, 1, 1024
        H, Sk, Dh = 32, 4096, 128
        return {
            "x": _w((lambda *s: torch.randn(*s, dtype=torch.bfloat16) * 0.05)(B, Sq, D)),
            "k_cache": _w((lambda *s: torch.randn(*s, dtype=torch.bfloat16) * 6.4)(B, H, Sk, Dh)),
            "v_cache": _w((lambda *s: torch.randn(*s, dtype=torch.bfloat16) * 0.05)(B, H, Sk, Dh)),
            "wq": _w((lambda *s: torch.randn(*s, dtype=torch.bfloat16) * 6.4)(D, H * Dh) * (D ** -0.5)),
            "wo": _w((lambda *s: torch.randn(*s, dtype=torch.bfloat16) * 0.05)(H * Dh, D) * ((H * Dh) ** -0.5)),
        }
    _A_in = _A_setup()

    def _B_setup():
        B, Sq, D = 8, 1, 1024
        Hq, Hkv, Sk, Dh = 32, 4, 4096, 128
        assert Hq % Hkv == 0, (Hq, Hkv)
        return {
            "x": _w((lambda *s: torch.randn(*s, dtype=torch.bfloat16) * 0.05)(B, Sq, D)),
            "k_cache": _w((lambda *s: torch.randn(*s, dtype=torch.bfloat16) * 6.4)(B, Hkv, Sk, Dh)),
            "v_cache": _w((lambda *s: torch.randn(*s, dtype=torch.bfloat16) * 0.05)(B, Hkv, Sk, Dh)),
            "wq": _w((lambda *s: torch.randn(*s, dtype=torch.bfloat16) * 6.4)(D, Hq * Dh) * (D ** -0.5)),
            "wo": _w((lambda *s: torch.randn(*s, dtype=torch.bfloat16) * 0.05)(Hq * Dh, D) * ((Hq * Dh) ** -0.5)),
        }
    _B_in = _B_setup()

    return {
        "A_x": _A_in["x"],
        "A_k_cache": _A_in["k_cache"],
        "A_v_cache": _A_in["v_cache"],
        "A_wq": _A_in["wq"],
        "A_wo": _A_in["wo"],
        "B_x": _B_in["x"],
        "B_k_cache": _B_in["k_cache"],
        "B_v_cache": _B_in["v_cache"],
        "B_wq": _B_in["wq"],
        "B_wo": _B_in["wo"],
        "gate_w": _w((lambda *s: torch.randn(*s, dtype=torch.bfloat16) * 0.05)(1024) * 16.0),
    }

def reference(A_x, A_k_cache, A_v_cache, A_wq, A_wo, B_x, B_k_cache, B_v_cache, B_wq, B_wo, gate_w):
    def _A_ref(x, k_cache, v_cache, wq, wo):
        B, Sq, D = x.shape
        H, Dh = 32, 128
        q = (lambda x, *d: x.permute(*d))((x @ wq).reshape(B, Sq, H, Dh), 0, 2, 1, 3)
        scores = torch.einsum("bhqd,bhkd->bhqk", q, k_cache) * (Dh ** -0.5)
        p = _softmax(scores, axis=-1)
        o = torch.einsum("bhqk,bhkd->bhqd", p, v_cache)
        return (lambda x, *d: x.permute(*d))(o, 0, 2, 1, 3).reshape(B, Sq, H * Dh) @ wo

    def _B_ref(x, k_cache, v_cache, wq, wo):
        B, Sq, D = x.shape
        Hq, Dh = 32, 128
        Hkv = k_cache.shape[1]
        rep = Hq // Hkv
        q = (lambda x, *d: x.permute(*d))((x @ wq).reshape(B, Sq, Hq, Dh), 0, 2, 1, 3)
        k = (lambda x, n, axis: torch.repeat_interleave(x, n, dim=axis))(k_cache, rep, axis=1)
        v = (lambda x, n, axis: torch.repeat_interleave(x, n, dim=axis))(v_cache, rep, axis=1)
        scores = torch.einsum("bhqd,bhkd->bhqk", q, k) * (Dh ** -0.5)
        p = _softmax(scores, axis=-1)
        o = torch.einsum("bhqk,bhkd->bhqd", p, v)
        return (lambda x, *d: x.permute(*d))(o, 0, 2, 1, 3).reshape(B, Sq, Hq * Dh) @ wo

    x = A_x
    g = _sigmoid((x * gate_w).sum(-1, keepdims=True))
    a = _A_ref(x, A_k_cache, A_v_cache, A_wq, A_wo)
    b = _B_ref(x, B_k_cache, B_v_cache, B_wq, B_wo)
    return g * a + (1 - g) * b
```

```asm
; @launch grid=(256,1,1) block=(512,1,1) lds=49152
.amdgcn_target "amdgcn-amd-amdhsa--gfx950"
.text
.globl gated_mix__mha_block_cached__gqa_block_cached__decode_kernel
.p2align 8
.type gated_mix__mha_block_cached__gqa_block_cached__decode_kernel,@function
gated_mix__mha_block_cached__gqa_block_cached__decode_kernel:
    s_cmp_ge_u32 s2, 256
    s_cbranch_scc1 L_end
    s_load_dwordx16 s[36:51], s[0:1], 0
    s_load_dwordx8 s[52:59], s[0:1], 64
    s_load_dwordx4 s[60:63], s[0:1], 96
    s_and_b32 s76, s2, 31
    s_lshr_b32 s77, s2, 5
    v_lshrrev_b32 v6, 6, v0
    v_and_b32 v1, 63, v0
    v_readfirstlane_b32 s78, v6
    v_lshrrev_b32 v2, 4, v1
    v_and_b32 v3, 15, v1
    s_mov_b32 s91, s2
    v_and_b32 v9, 7, v3
    v_lshlrev_b32 v9, 11, v9
    v_lshl_add_u32 v9, v2, 4, v9
    v_lshlrev_b32 v11, 16, v2
    v_lshl_add_u32 v11, v3, 4, v11
    v_lshlrev_b32 v5, 4, v1
    s_and_b32 s79, s77, 3
    s_lshl_b32 s79, s79, 8
    s_lshl_b32 s80, s78, 5
    s_add_u32 s79, s79, s80
    s_lshl_b32 s80, s79, 1
    s_lshl_b32 s79, s79, 13
    s_lshl_b32 s87, s76, 8
    s_add_u32 s79, s79, s87
    s_cmp_lt_u32 s77, 4
    s_waitcnt lgkmcnt(0)
    s_cselect_b32 s81, s42, s52
    s_cselect_b32 s82, s43, s53
    s_mov_b32 s20, s81
    s_and_b32 s21, s82, 0xffff
    s_mov_b32 s22, 0x800000
    s_mov_b32 s23, 0x00020000
    s_mov_b32 s28, s36
    s_and_b32 s29, s37, 0xffff
    s_mov_b32 s30, 0x4000
    s_mov_b32 s31, 0x00020000
    buffer_load_dwordx4 v[160:163], v11, s[20:23], s79 offen nt
    s_add_u32 s79, s79, 0x2000
    buffer_load_dwordx4 v[164:167], v11, s[20:23], s79 offen nt
    s_add_u32 s79, s79, 0x2000
    buffer_load_dwordx4 v[168:171], v11, s[20:23], s79 offen nt
    s_add_u32 s79, s79, 0x2000
    buffer_load_dwordx4 v[172:175], v11, s[20:23], s79 offen nt
    s_add_u32 s79, s79, 0x2000
    buffer_load_dwordx4 v[176:179], v11, s[20:23], s79 offen nt
    s_add_u32 s79, s79, 0x2000
    buffer_load_dwordx4 v[180:183], v11, s[20:23], s79 offen nt
    s_add_u32 s79, s79, 0x2000
    buffer_load_dwordx4 v[184:187], v11, s[20:23], s79 offen nt
    s_add_u32 s79, s79, 0x2000
    buffer_load_dwordx4 v[188:191], v11, s[20:23], s79 offen nt
    buffer_load_dwordx4 v[28:31], v9, s[28:31], s80 offen
    s_mov_b32 s53, 0x280000
    s_load_dword s52, s[62:63], s53
    s_mov_b32 s32, s62
    s_and_b32 s33, s63, 0xffff
    s_mov_b32 s34, 0x410000
    s_mov_b32 s35, 0x00020000
    v_mov_b32 v48, -1
    v_mov_b32 v49, -1
    v_mov_b32 v50, -1
    v_mov_b32 v51, -1
    v_mov_b32 v52, 0
    v_mov_b32 v53, 0
    v_mov_b32 v54, 0
    v_mov_b32 v55, 0
    ds_write_b128 v52, v[52:55] offset:11200
    ds_write_b128 v52, v[52:55] offset:11216
    ds_write_b128 v52, v[52:55] offset:11232
    s_lshl_b32 s79, s91, 3
    s_add_u32 s79, s79, s78
    s_lshl_b32 s79, s79, 9
    s_add_u32 s79, s79, 0x300000
    s_and_b32 s80, s91, 0xf8
    s_add_u32 s80, s80, s78
    s_lshl_b32 s80, s80, 3
    s_and_b32 s81, s91, 7
    s_add_u32 s80, s80, s81
    s_lshl_b32 s80, s80, 9
    s_add_u32 s80, s80, 0xffe00
    v_mov_b32 v6, s79
    v_mov_b32 v7, s80
    v_cmp_gt_u32 vcc, 32, v1
    s_nop 1
    v_cndmask_b32 v6, v7, v6, vcc
    v_add_u32 v6, v6, v5
    buffer_store_dwordx4 v[48:51], v6, s[32:35], 0 offen sc1
    s_lshr_b32 s79, s78, 2
    s_lshl_b32 s81, s76, 1
    s_add_u32 s79, s79, s81
    s_lshl_b32 s79, s79, 3
    s_add_u32 s79, s79, s77
    s_lshl_b32 s79, s79, 8
    s_and_b32 s81, s78, 3
    s_lshl_b32 s81, s81, 6
    s_add_u32 s79, s79, s81
    s_add_u32 s79, s79, 0x210000
    s_sub_u32 s80, s80, 0xffe00
    s_lshr_b32 s80, s80, 5
    s_add_u32 s80, s80, 0x200000
    v_add_u32 v6, s79, v5
    v_mov_b32 v7, s80
    v_mov_b32 v8, 0x7ffffff0
    v_cmp_eq_u32 vcc, 4, v1
    s_nop 1
    v_cndmask_b32 v7, v8, v7, vcc
    v_cmp_gt_u32 vcc, 4, v1
    s_nop 1
    v_cndmask_b32 v6, v7, v6, vcc
    buffer_store_dwordx4 v[48:51], v6, s[32:35], 0 offen sc1
    s_lshl_b32 s79, s91, 20
    s_lshl_b32 s80, s91, 17
    s_add_u32 s4, s38, s79
    s_addc_u32 s5, s39, 0
    s_and_b32 s5, s5, 0xffff
    s_mov_b32 s6, 0x100000
    s_mov_b32 s7, 0x00020000
    v_and_b32 v6, 3, v3
    v_lshrrev_b32 v7, 2, v3
    v_lshl_add_u32 v6, v6, 2, v7
    v_lshlrev_b32 v6, 8, v6
    v_lshl_add_u32 v4, v2, 4, v6
    s_mov_b32 s72, s56
    s_and_b32 s73, s57, 0xffff
    s_mov_b32 s74, 0x800
    s_mov_b32 s75, 0x00020000
    s_lshl_b32 s87, s78, 13
    s_add_u32 s88, s87, 0x1000
    s_add_u32 s8, s40, s79
    s_addc_u32 s9, s41, 0
    s_and_b32 s9, s9, 0xffff
    s_mov_b32 s10, 0x100000
    s_mov_b32 s11, 0x00020000
    s_add_u32 s12, s48, s80
    s_addc_u32 s13, s49, 0
    s_and_b32 s13, s13, 0xffff
    s_mov_b32 s14, 0x20000
    s_mov_b32 s15, 0x00020000
    s_add_u32 s16, s50, s80
    s_addc_u32 s17, s51, 0
    s_and_b32 s17, s17, 0xffff
    s_mov_b32 s18, 0x20000
    s_mov_b32 s19, 0x00020000
    s_cmp_lt_u32 s78, 4
    s_cselect_b32 s81, s44, s54
    s_cselect_b32 s82, s45, s55
    s_mov_b32 s24, s81
    s_and_b32 s25, s82, 0xffff
    s_mov_b32 s26, 0x800000
    s_mov_b32 s27, 0x00020000
    s_mov_b32 s64, s60
    s_and_b32 s65, s61, 0xffff
    s_mov_b32 s66, 0x100
    s_mov_b32 s67, 0x00020000
    s_mov_b32 s68, s58
    s_and_b32 s69, s59, 0xffff
    s_mov_b32 s70, 0x4000
    s_mov_b32 s71, 0x00020000
    s_mov_b32 s83, 0x05040100
    s_mov_b32 s84, 0x07060302
    s_mov_b32 s85, 0x3db504f3
    s_mov_b32 s86, 0x3fb8aa3b
    s_mov_b32 s90, 400000
    s_mov_b32 s48, 0
    s_mov_b32 s49, 0
    s_add_u32 s50, s78, 16
    s_mov_b32 s51, 0
    s_mov_b32 s56, 120
    s_add_u32 s50, s78, 20
    s_add_u32 s82, s78, 16
    s_cmp_lt_u32 s78, 4
    s_cselect_b32 s50, s50, s82
    s_cselect_b32 s56, s56, 24
    s_mov_b32 s44, 0x07060500
    s_mov_b32 s45, 0x07060501
    s_mov_b32 s46, 0x07060502
    s_mov_b32 s47, 0x07060503
    s_mov_b32 s54, 0x0c0c0400
    s_mov_b32 s55, 0x04000c0c
    s_mul_i32 s79, s78, 4224
    v_mul_u32_u24 v12, 528, v3
    v_add_u32 v12, s79, v12
    v_lshl_add_u32 v12, v2, 4, v12
    v_lshrrev_b32 v6, 5, v1
    v_mul_u32_u24 v7, 16896, v6
    v_and_b32 v8, 31, v1
    v_lshlrev_b32 v8, 4, v8
    s_mul_i32 s79, s78, 528
    v_add3_u32 v7, v7, v8, s79
    v_lshl_add_u32 v13, v6, 13, v8
    v_mov_b32 v9, 0x7ffffff0
    v_cmp_gt_u32 vcc, 32, v1
    s_nop 1
    v_cndmask_b32 v8, v9, v8, vcc
    s_lshr_b32 s79, s77, 2
    s_lshl_b32 s79, s79, 5
    s_add_u32 s79, s79, s76
    s_lshl_b32 s79, s79, 2
    s_and_b32 s80, s77, 3
    s_add_u32 s79, s79, s80
    s_lshl_b32 s79, s79, 12
    s_lshl_b32 s80, s78, 9
    s_add_u32 s79, s79, s80
    s_waitcnt vmcnt(2) lgkmcnt(0)
    s_xor_b32 s53, s52, 0x5bd1e995
    v_mov_b32 v19, s53
    v_perm_b32 v80, v164, v160, s83
    v_perm_b32 v81, v172, v168, s83
    v_perm_b32 v82, v180, v176, s83
    v_perm_b32 v83, v188, v184, s83
    v_perm_b32 v84, v164, v160, s84
    v_perm_b32 v85, v172, v168, s84
    v_perm_b32 v86, v180, v176, s84
    v_perm_b32 v87, v188, v184, s84
    v_mfma_f32_16x16x32_bf16 v[48:51], v[80:83], v[28:31], 0
    v_perm_b32 v88, v165, v161, s83
    v_perm_b32 v89, v173, v169, s83
    v_perm_b32 v90, v181, v177, s83
    v_perm_b32 v91, v189, v185, s83
    v_mfma_f32_16x16x32_bf16 v[52:55], v[84:87], v[28:31], 0
    v_perm_b32 v92, v165, v161, s84
    v_perm_b32 v93, v173, v169, s84
    v_perm_b32 v94, v181, v177, s84
    v_perm_b32 v95, v189, v185, s84
    v_mfma_f32_16x16x32_bf16 v[56:59], v[88:91], v[28:31], 0
    v_perm_b32 v80, v166, v162, s83
    v_perm_b32 v81, v174, v170, s83
    v_perm_b32 v82, v182, v178, s83
    v_perm_b32 v83, v190, v186, s83
    v_mfma_f32_16x16x32_bf16 v[60:63], v[92:95], v[28:31], 0
    v_perm_b32 v84, v166, v162, s84
    v_perm_b32 v85, v174, v170, s84
    v_perm_b32 v86, v182, v178, s84
    v_perm_b32 v87, v190, v186, s84
    v_mfma_f32_16x16x32_bf16 v[64:67], v[80:83], v[28:31], 0
    v_perm_b32 v88, v167, v163, s83
    v_perm_b32 v89, v175, v171, s83
    v_perm_b32 v90, v183, v179, s83
    v_perm_b32 v91, v191, v187, s83
    v_mfma_f32_16x16x32_bf16 v[68:71], v[84:87], v[28:31], 0
    v_perm_b32 v92, v167, v163, s84
    v_perm_b32 v93, v175, v171, s84
    v_perm_b32 v94, v183, v179, s84
    v_perm_b32 v95, v191, v187, s84
    v_mfma_f32_16x16x32_bf16 v[72:75], v[88:91], v[28:31], 0
    s_nop 1
    v_mfma_f32_16x16x32_bf16 v[76:79], v[92:95], v[28:31], 0
    s_mov_b32 exec_lo, 0x00ff00ff
    s_mov_b32 exec_hi, 0x00ff00ff
    s_nop 5
    ds_write_b128 v12, v[48:51] offset:15360
    ds_write_b128 v12, v[52:55] offset:15424
    ds_write_b128 v12, v[56:59] offset:15488
    ds_write_b128 v12, v[60:63] offset:15552
    ds_write_b128 v12, v[64:67] offset:15616
    ds_write_b128 v12, v[68:71] offset:15680
    ds_write_b128 v12, v[72:75] offset:15744
    ds_write_b128 v12, v[76:79] offset:15808
    s_mov_b64 exec, -1
    s_waitcnt lgkmcnt(0)
    s_barrier
    ds_read_b128 v[160:163], v7 offset:15360
    ds_read_b128 v[164:167], v7 offset:19584
    ds_read_b128 v[168:171], v7 offset:23808
    ds_read_b128 v[172:175], v7 offset:28032
    s_waitcnt lgkmcnt(0)
    v_add_f32 v160, v160, v168
    v_add_f32 v161, v161, v169
    v_add_f32 v162, v162, v170
    v_add_f32 v163, v163, v171
    v_add_f32 v164, v164, v172
    v_add_f32 v165, v165, v173
    v_add_f32 v166, v166, v174
    v_add_f32 v167, v167, v175
    v_add_f32 v160, v160, v164
    v_add_f32 v161, v161, v165
    v_add_f32 v162, v162, v166
    v_add_f32 v163, v163, v167
    v_mov_b32 v164, v160
    v_mov_b32 v165, v161
    v_mov_b32 v166, v162
    v_mov_b32 v167, v163
    s_nop 0
    v_permlane32_swap_b32 v164, v160
    v_permlane32_swap_b32 v165, v161
    v_permlane32_swap_b32 v166, v162
    v_permlane32_swap_b32 v167, v163
    s_nop 0
    v_add_f32 v160, v160, v164
    v_add_f32 v161, v161, v165
    v_add_f32 v162, v162, v166
    v_add_f32 v163, v163, v167
    v_perm_b32 v160, v160, v19, s44
    v_perm_b32 v161, v161, v19, s45
    v_perm_b32 v162, v162, v19, s46
    v_perm_b32 v163, v163, v19, s47
    buffer_store_dwordx4 v[160:163], v8, s[32:35], s79 offen sc1
    buffer_load_dwordx4 v[96:99], v4, s[4:7], s87 offen offset:0 nt
    buffer_load_dwordx4 v[100:103], v4, s[4:7], s87 offen offset:64 nt
    buffer_load_dwordx4 v[104:107], v4, s[4:7], s87 offen offset:128 nt
    buffer_load_dwordx4 v[108:111], v4, s[4:7], s87 offen offset:192 nt
    buffer_load_dwordx4 v[112:115], v4, s[4:7], s88 offen offset:0 nt
    buffer_load_dwordx4 v[116:119], v4, s[4:7], s88 offen offset:64 nt
    buffer_load_dwordx4 v[120:123], v4, s[4:7], s88 offen offset:128 nt
    buffer_load_dwordx4 v[124:127], v4, s[4:7], s88 offen offset:192 nt
    s_barrier
    s_cmp_eq_u32 s78, 0
    s_cbranch_scc1 L_w0
    s_nop 0
    buffer_load_dwordx4 v[128:131], v5, s[8:11], s87 offen offset:0 nt
    buffer_load_dwordx4 v[132:135], v5, s[8:11], s87 offen offset:1024 nt
    buffer_load_dwordx4 v[136:139], v5, s[8:11], s87 offen offset:2048 nt
    buffer_load_dwordx4 v[140:143], v5, s[8:11], s87 offen offset:3072 nt
    buffer_load_dwordx4 v[144:147], v5, s[8:11], s88 offen offset:0 nt
    buffer_load_dwordx4 v[148:151], v5, s[8:11], s88 offen offset:1024 nt
    buffer_load_dwordx4 v[152:155], v5, s[8:11], s88 offen offset:2048 nt
    buffer_load_dwordx4 v[156:159], v5, s[8:11], s88 offen offset:3072 nt
    s_add_u32 s87, s87, 0x10000
    s_add_u32 s88, s87, 0x1000
    s_waitcnt vmcnt(8)
    s_barrier
    s_branch L_go
L_w0:
    v_mov_b32 v9, 0x7ffffff0
    v_mov_b32 v11, s91
    v_cmp_eq_u32 vcc, 0, v1
    v_mov_b32 v10, 1
    v_cndmask_b32 v9, v9, v11, vcc
    s_lshl_b32 s80, s77, 9
    s_lshl_b32 s79, s76, 14
    s_add_u32 s79, s79, s80
    s_add_u32 s81, s79, 0x1000
    v_and_b32 v7, 3, v1
    v_lshlrev_b32 v7, 6, v7
    v_bfe_u32 v8, v1, 2, 3
    v_lshl_add_u32 v7, v8, 1, v7
L_pollQ:
    buffer_load_dwordx4 v[224:227], v13, s[32:35], s79 offen sc1
    buffer_load_dwordx4 v[228:231], v13, s[32:35], s81 offen sc1
    s_waitcnt vmcnt(0)
    v_perm_b32 v14, v225, v224, s54
    v_perm_b32 v15, v227, v226, s55
    v_or_b32 v14, v14, v15
    v_xor_b32 v6, v14, v19
    v_perm_b32 v14, v229, v228, s54
    v_perm_b32 v15, v231, v230, s55
    v_or_b32 v14, v14, v15
    v_xor_b32 v14, v14, v19
    v_or_b32 v6, v6, v14
    v_cmp_ne_u32 vcc, 0, v6
    s_cbranch_vccz L_pollQ_done
    s_sub_u32 s90, s90, 1
    s_cbranch_scc1 L_pollQ_done
    s_sleep 1
    s_branch L_pollQ
L_pollQ_done:
    v_and_b32 v224, 0xffffff00, v224
    v_and_b32 v225, 0xffffff00, v225
    v_and_b32 v226, 0xffffff00, v226
    v_and_b32 v227, 0xffffff00, v227
    v_and_b32 v228, 0xffffff00, v228
    v_and_b32 v229, 0xffffff00, v229
    v_and_b32 v230, 0xffffff00, v230
    v_and_b32 v231, 0xffffff00, v231
    v_add_f32 v224, v224, v228
    v_add_f32 v225, v225, v229
    v_add_f32 v226, v226, v230
    v_add_f32 v227, v227, v231
    v_mov_b32 v228, v224
    v_mov_b32 v229, v225
    v_mov_b32 v230, v226
    v_mov_b32 v231, v227
    s_nop 0
    v_permlane32_swap_b32 v228, v224
    v_permlane32_swap_b32 v229, v225
    v_permlane32_swap_b32 v230, v226
    v_permlane32_swap_b32 v231, v227
    s_nop 0
    v_add_f32 v224, v224, v228
    v_add_f32 v225, v225, v229
    v_add_f32 v226, v226, v230
    v_add_f32 v227, v227, v231
    v_cvt_pk_bf16_f32 v224, v224, v225
    v_cvt_pk_bf16_f32 v225, v226, v227
    ds_write_b16 v7, v224 offset:8832
    ds_write_b16_d16_hi v7, v224 offset:8848
    ds_write_b16 v7, v225 offset:8864
    ds_write_b16_d16_hi v7, v225 offset:8880
    s_waitcnt lgkmcnt(0)
    s_barrier
    buffer_store_byte v10, v9, s[64:67], 0 offen sc1
    buffer_load_dwordx4 v[128:131], v5, s[8:11], s87 offen offset:0 nt
    buffer_load_dwordx4 v[132:135], v5, s[8:11], s87 offen offset:1024 nt
    buffer_load_dwordx4 v[136:139], v5, s[8:11], s87 offen offset:2048 nt
    buffer_load_dwordx4 v[140:143], v5, s[8:11], s87 offen offset:3072 nt
    buffer_load_dwordx4 v[144:147], v5, s[8:11], s88 offen offset:0 nt
    buffer_load_dwordx4 v[148:151], v5, s[8:11], s88 offen offset:1024 nt
    buffer_load_dwordx4 v[152:155], v5, s[8:11], s88 offen offset:2048 nt
    buffer_load_dwordx4 v[156:159], v5, s[8:11], s88 offen offset:3072 nt
L_pollQB:
    s_and_b32 s79, s76, 0x18
    s_add_u32 s79, s79, 32
    s_lshl_b32 s79, s79, 14
    s_add_u32 s79, s79, s80
    s_add_u32 s81, s79, 0x1000
    buffer_load_dwordx4 v[160:163], v13, s[32:35], s79 offen sc1
    buffer_load_dwordx4 v[164:167], v13, s[32:35], s81 offen sc1
    s_add_u32 s79, s79, 0x4000
    s_add_u32 s81, s79, 0x1000
    buffer_load_dwordx4 v[168:171], v13, s[32:35], s79 offen sc1
    buffer_load_dwordx4 v[172:175], v13, s[32:35], s81 offen sc1
    s_add_u32 s79, s79, 0x4000
    s_add_u32 s81, s79, 0x1000
    buffer_load_dwordx4 v[176:179], v13, s[32:35], s79 offen sc1
    buffer_load_dwordx4 v[180:183], v13, s[32:35], s81 offen sc1
    s_add_u32 s79, s79, 0x4000
    s_add_u32 s81, s79, 0x1000
    buffer_load_dwordx4 v[184:187], v13, s[32:35], s79 offen sc1
    buffer_load_dwordx4 v[188:191], v13, s[32:35], s81 offen sc1
    s_add_u32 s79, s79, 0x4000
    s_add_u32 s81, s79, 0x1000
    buffer_load_dwordx4 v[192:195], v13, s[32:35], s79 offen sc1
    buffer_load_dwordx4 v[196:199], v13, s[32:35], s81 offen sc1
    s_add_u32 s79, s79, 0x4000
    s_add_u32 s81, s79, 0x1000
    buffer_load_dwordx4 v[200:203], v13, s[32:35], s79 offen sc1
    buffer_load_dwordx4 v[204:207], v13, s[32:35], s81 offen sc1
    s_add_u32 s79, s79, 0x4000
    s_add_u32 s81, s79, 0x1000
    buffer_load_dwordx4 v[208:211], v13, s[32:35], s79 offen sc1
    buffer_load_dwordx4 v[212:215], v13, s[32:35], s81 offen sc1
    s_add_u32 s79, s79, 0x4000
    s_add_u32 s81, s79, 0x1000
    buffer_load_dwordx4 v[216:219], v13, s[32:35], s79 offen sc1
    buffer_load_dwordx4 v[220:223], v13, s[32:35], s81 offen sc1
    s_waitcnt vmcnt(0)
    v_perm_b32 v14, v161, v160, s54
    v_perm_b32 v15, v163, v162, s55
    v_or_b32 v14, v14, v15
    v_xor_b32 v6, v14, v19
    v_perm_b32 v14, v165, v164, s54
    v_perm_b32 v15, v167, v166, s55
    v_or_b32 v14, v14, v15
    v_xor_b32 v14, v14, v19
    v_or_b32 v6, v6, v14
    v_perm_b32 v14, v169, v168, s54
    v_perm_b32 v15, v171, v170, s55
    v_or_b32 v14, v14, v15
    v_xor_b32 v14, v14, v19
    v_or_b32 v6, v6, v14
    v_perm_b32 v14, v173, v172, s54
    v_perm_b32 v15, v175, v174, s55
    v_or_b32 v14, v14, v15
    v_xor_b32 v14, v14, v19
    v_or_b32 v6, v6, v14
    v_perm_b32 v14, v177, v176, s54
    v_perm_b32 v15, v179, v178, s55
    v_or_b32 v14, v14, v15
    v_xor_b32 v14, v14, v19
    v_or_b32 v6, v6, v14
    v_perm_b32 v14, v181, v180, s54
    v_perm_b32 v15, v183, v182, s55
    v_or_b32 v14, v14, v15
    v_xor_b32 v14, v14, v19
    v_or_b32 v6, v6, v14
    v_perm_b32 v14, v185, v184, s54
    v_perm_b32 v15, v187, v186, s55
    v_or_b32 v14, v14, v15
    v_xor_b32 v14, v14, v19
    v_or_b32 v6, v6, v14
    v_perm_b32 v14, v189, v188, s54
    v_perm_b32 v15, v191, v190, s55
    v_or_b32 v14, v14, v15
    v_xor_b32 v14, v14, v19
    v_or_b32 v6, v6, v14
    v_perm_b32 v14, v193, v192, s54
    v_perm_b32 v15, v195, v194, s55
    v_or_b32 v14, v14, v15
    v_xor_b32 v14, v14, v19
    v_or_b32 v6, v6, v14
    v_perm_b32 v14, v197, v196, s54
    v_perm_b32 v15, v199, v198, s55
    v_or_b32 v14, v14, v15
    v_xor_b32 v14, v14, v19
    v_or_b32 v6, v6, v14
    v_perm_b32 v14, v201, v200, s54
    v_perm_b32 v15, v203, v202, s55
    v_or_b32 v14, v14, v15
    v_xor_b32 v14, v14, v19
    v_or_b32 v6, v6, v14
    v_perm_b32 v14, v205, v204, s54
    v_perm_b32 v15, v207, v206, s55
    v_or_b32 v14, v14, v15
    v_xor_b32 v14, v14, v19
    v_or_b32 v6, v6, v14
    v_perm_b32 v14, v209, v208, s54
    v_perm_b32 v15, v211, v210, s55
    v_or_b32 v14, v14, v15
    v_xor_b32 v14, v14, v19
    v_or_b32 v6, v6, v14
    v_perm_b32 v14, v213, v212, s54
    v_perm_b32 v15, v215, v214, s55
    v_or_b32 v14, v14, v15
    v_xor_b32 v14, v14, v19
    v_or_b32 v6, v6, v14
    v_perm_b32 v14, v217, v216, s54
    v_perm_b32 v15, v219, v218, s55
    v_or_b32 v14, v14, v15
    v_xor_b32 v14, v14, v19
    v_or_b32 v6, v6, v14
    v_perm_b32 v14, v221, v220, s54
    v_perm_b32 v15, v223, v222, s55
    v_or_b32 v14, v14, v15
    v_xor_b32 v14, v14, v19
    v_or_b32 v6, v6, v14
    v_cmp_ne_u32 vcc, 0, v6
    s_cbranch_vccz L_pollQB_done
    s_sub_u32 s90, s90, 1
    s_cbranch_scc1 L_pollQB_done
    s_sleep 1
    s_branch L_pollQB
L_pollQB_done:
    v_and_b32 v160, 0xffffff00, v160
    v_and_b32 v161, 0xffffff00, v161
    v_and_b32 v162, 0xffffff00, v162
    v_and_b32 v163, 0xffffff00, v163
    v_and_b32 v164, 0xffffff00, v164
    v_and_b32 v165, 0xffffff00, v165
    v_and_b32 v166, 0xffffff00, v166
    v_and_b32 v167, 0xffffff00, v167
    v_and_b32 v168, 0xffffff00, v168
    v_and_b32 v169, 0xffffff00, v169
    v_and_b32 v170, 0xffffff00, v170
    v_and_b32 v171, 0xffffff00, v171
    v_and_b32 v172, 0xffffff00, v172
    v_and_b32 v173, 0xffffff00, v173
    v_and_b32 v174, 0xffffff00, v174
    v_and_b32 v175, 0xffffff00, v175
    v_and_b32 v176, 0xffffff00, v176
    v_and_b32 v177, 0xffffff00, v177
    v_and_b32 v178, 0xffffff00, v178
    v_and_b32 v179, 0xffffff00, v179
    v_and_b32 v180, 0xffffff00, v180
    v_and_b32 v181, 0xffffff00, v181
    v_and_b32 v182, 0xffffff00, v182
    v_and_b32 v183, 0xffffff00, v183
    v_and_b32 v184, 0xffffff00, v184
    v_and_b32 v185, 0xffffff00, v185
    v_and_b32 v186, 0xffffff00, v186
    v_and_b32 v187, 0xffffff00, v187
    v_and_b32 v188, 0xffffff00, v188
    v_and_b32 v189, 0xffffff00, v189
    v_and_b32 v190, 0xffffff00, v190
    v_and_b32 v191, 0xffffff00, v191
    v_and_b32 v192, 0xffffff00, v192
    v_and_b32 v193, 0xffffff00, v193
    v_and_b32 v194, 0xffffff00, v194
    v_and_b32 v195, 0xffffff00, v195
    v_and_b32 v196, 0xffffff00, v196
    v_and_b32 v197, 0xffffff00, v197
    v_and_b32 v198, 0xffffff00, v198
    v_and_b32 v199, 0xffffff00, v199
    v_and_b32 v200, 0xffffff00, v200
    v_and_b32 v201, 0xffffff00, v201
    v_and_b32 v202, 0xffffff00, v202
    v_and_b32 v203, 0xffffff00, v203
    v_and_b32 v204, 0xffffff00, v204
    v_and_b32 v205, 0xffffff00, v205
    v_and_b32 v206, 0xffffff00, v206
    v_and_b32 v207, 0xffffff00, v207
    v_and_b32 v208, 0xffffff00, v208
    v_and_b32 v209, 0xffffff00, v209
    v_and_b32 v210, 0xffffff00, v210
    v_and_b32 v211, 0xffffff00, v211
    v_and_b32 v212, 0xffffff00, v212
    v_and_b32 v213, 0xffffff00, v213
    v_and_b32 v214, 0xffffff00, v214
    v_and_b32 v215, 0xffffff00, v215
    v_and_b32 v216, 0xffffff00, v216
    v_and_b32 v217, 0xffffff00, v217
    v_and_b32 v218, 0xffffff00, v218
    v_and_b32 v219, 0xffffff00, v219
    v_and_b32 v220, 0xffffff00, v220
    v_and_b32 v221, 0xffffff00, v221
    v_and_b32 v222, 0xffffff00, v222
    v_and_b32 v223, 0xffffff00, v223
    v_add_f32 v160, v160, v164
    v_add_f32 v161, v161, v165
    v_add_f32 v162, v162, v166
    v_add_f32 v163, v163, v167
    v_mov_b32 v164, v160
    v_mov_b32 v165, v161
    v_mov_b32 v166, v162
    v_mov_b32 v167, v163
    s_nop 0
    v_permlane32_swap_b32 v164, v160
    v_permlane32_swap_b32 v165, v161
    v_permlane32_swap_b32 v166, v162
    v_permlane32_swap_b32 v167, v163
    s_nop 0
    v_add_f32 v160, v160, v164
    v_add_f32 v161, v161, v165
    v_add_f32 v162, v162, v166
    v_add_f32 v163, v163, v167
    v_cvt_pk_bf16_f32 v160, v160, v161
    v_cvt_pk_bf16_f32 v161, v162, v163
    ds_write_b16 v7, v160 offset:9088
    ds_write_b16_d16_hi v7, v160 offset:9104
    ds_write_b16 v7, v161 offset:9120
    ds_write_b16_d16_hi v7, v161 offset:9136
    v_add_f32 v168, v168, v172
    v_add_f32 v169, v169, v173
    v_add_f32 v170, v170, v174
    v_add_f32 v171, v171, v175
    v_mov_b32 v172, v168
    v_mov_b32 v173, v169
    v_mov_b32 v174, v170
    v_mov_b32 v175, v171
    s_nop 0
    v_permlane32_swap_b32 v172, v168
    v_permlane32_swap_b32 v173, v169
    v_permlane32_swap_b32 v174, v170
    v_permlane32_swap_b32 v175, v171
    s_nop 0
    v_add_f32 v168, v168, v172
    v_add_f32 v169, v169, v173
    v_add_f32 v170, v170, v174
    v_add_f32 v171, v171, v175
    v_cvt_pk_bf16_f32 v168, v168, v169
    v_cvt_pk_bf16_f32 v169, v170, v171
    ds_write_b16 v7, v168 offset:9344
    ds_write_b16_d16_hi v7, v168 offset:9360
    ds_write_b16 v7, v169 offset:9376
    ds_write_b16_d16_hi v7, v169 offset:9392
    v_add_f32 v176, v176, v180
    v_add_f32 v177, v177, v181
    v_add_f32 v178, v178, v182
    v_add_f32 v179, v179, v183
    v_mov_b32 v180, v176
    v_mov_b32 v181, v177
    v_mov_b32 v182, v178
    v_mov_b32 v183, v179
    s_nop 0
    v_permlane32_swap_b32 v180, v176
    v_permlane32_swap_b32 v181, v177
    v_permlane32_swap_b32 v182, v178
    v_permlane32_swap_b32 v183, v179
    s_nop 0
    v_add_f32 v176, v176, v180
    v_add_f32 v177, v177, v181
    v_add_f32 v178, v178, v182
    v_add_f32 v179, v179, v183
    v_cvt_pk_bf16_f32 v176, v176, v177
    v_cvt_pk_bf16_f32 v177, v178, v179
    ds_write_b16 v7, v176 offset:9600
    ds_write_b16_d16_hi v7, v176 offset:9616
    ds_write_b16 v7, v177 offset:9632
    ds_write_b16_d16_hi v7, v177 offset:9648
    v_add_f32 v184, v184, v188
    v_add_f32 v185, v185, v189
    v_add_f32 v186, v186, v190
    v_add_f32 v187, v187, v191
    v_mov_b32 v188, v184
    v_mov_b32 v189, v185
    v_mov_b32 v190, v186
    v_mov_b32 v191, v187
    s_nop 0
    v_permlane32_swap_b32 v188, v184
    v_permlane32_swap_b32 v189, v185
    v_permlane32_swap_b32 v190, v186
    v_permlane32_swap_b32 v191, v187
    s_nop 0
    v_add_f32 v184, v184, v188
    v_add_f32 v185, v185, v189
    v_add_f32 v186, v186, v190
    v_add_f32 v187, v187, v191
    v_cvt_pk_bf16_f32 v184, v184, v185
    v_cvt_pk_bf16_f32 v185, v186, v187
    ds_write_b16 v7, v184 offset:9856
    ds_write_b16_d16_hi v7, v184 offset:9872
    ds_write_b16 v7, v185 offset:9888
    ds_write_b16_d16_hi v7, v185 offset:9904
    v_add_f32 v192, v192, v196
    v_add_f32 v193, v193, v197
    v_add_f32 v194, v194, v198
    v_add_f32 v195, v195, v199
    v_mov_b32 v196, v192
    v_mov_b32 v197, v193
    v_mov_b32 v198, v194
    v_mov_b32 v199, v195
    s_nop 0
    v_permlane32_swap_b32 v196, v192
    v_permlane32_swap_b32 v197, v193
    v_permlane32_swap_b32 v198, v194
    v_permlane32_swap_b32 v199, v195
    s_nop 0
    v_add_f32 v192, v192, v196
    v_add_f32 v193, v193, v197
    v_add_f32 v194, v194, v198
    v_add_f32 v195, v195, v199
    v_cvt_pk_bf16_f32 v192, v192, v193
    v_cvt_pk_bf16_f32 v193, v194, v195
    ds_write_b16 v7, v192 offset:10112
    ds_write_b16_d16_hi v7, v192 offset:10128
    ds_write_b16 v7, v193 offset:10144
    ds_write_b16_d16_hi v7, v193 offset:10160
    v_add_f32 v200, v200, v204
    v_add_f32 v201, v201, v205
    v_add_f32 v202, v202, v206
    v_add_f32 v203, v203, v207
    v_mov_b32 v204, v200
    v_mov_b32 v205, v201
    v_mov_b32 v206, v202
    v_mov_b32 v207, v203
    s_nop 0
    v_permlane32_swap_b32 v204, v200
    v_permlane32_swap_b32 v205, v201
    v_permlane32_swap_b32 v206, v202
    v_permlane32_swap_b32 v207, v203
    s_nop 0
    v_add_f32 v200, v200, v204
    v_add_f32 v201, v201, v205
    v_add_f32 v202, v202, v206
    v_add_f32 v203, v203, v207
    v_cvt_pk_bf16_f32 v200, v200, v201
    v_cvt_pk_bf16_f32 v201, v202, v203
    ds_write_b16 v7, v200 offset:10368
    ds_write_b16_d16_hi v7, v200 offset:10384
    ds_write_b16 v7, v201 offset:10400
    ds_write_b16_d16_hi v7, v201 offset:10416
    v_add_f32 v208, v208, v212
    v_add_f32 v209, v209, v213
    v_add_f32 v210, v210, v214
    v_add_f32 v211, v211, v215
    v_mov_b32 v212, v208
    v_mov_b32 v213, v209
    v_mov_b32 v214, v210
    v_mov_b32 v215, v211
    s_nop 0
    v_permlane32_swap_b32 v212, v208
    v_permlane32_swap_b32 v213, v209
    v_permlane32_swap_b32 v214, v210
    v_permlane32_swap_b32 v215, v211
    s_nop 0
    v_add_f32 v208, v208, v212
    v_add_f32 v209, v209, v213
    v_add_f32 v210, v210, v214
    v_add_f32 v211, v211, v215
    v_cvt_pk_bf16_f32 v208, v208, v209
    v_cvt_pk_bf16_f32 v209, v210, v211
    ds_write_b16 v7, v208 offset:10624
    ds_write_b16_d16_hi v7, v208 offset:10640
    ds_write_b16 v7, v209 offset:10656
    ds_write_b16_d16_hi v7, v209 offset:10672
    v_add_f32 v216, v216, v220
    v_add_f32 v217, v217, v221
    v_add_f32 v218, v218, v222
    v_add_f32 v219, v219, v223
    v_mov_b32 v220, v216
    v_mov_b32 v221, v217
    v_mov_b32 v222, v218
    v_mov_b32 v223, v219
    s_nop 0
    v_permlane32_swap_b32 v220, v216
    v_permlane32_swap_b32 v221, v217
    v_permlane32_swap_b32 v222, v218
    v_permlane32_swap_b32 v223, v219
    s_nop 0
    v_add_f32 v216, v216, v220
    v_add_f32 v217, v217, v221
    v_add_f32 v218, v218, v222
    v_add_f32 v219, v219, v223
    v_cvt_pk_bf16_f32 v216, v216, v217
    v_cvt_pk_bf16_f32 v217, v218, v219
    ds_write_b16 v7, v216 offset:10880
    ds_write_b16_d16_hi v7, v216 offset:10896
    ds_write_b16 v7, v217 offset:10912
    ds_write_b16_d16_hi v7, v217 offset:10928
    v_mov_b32 v6, 0
    v_mov_b32 v8, 8
    ds_write_b32 v6, v8 offset:11204
    s_waitcnt lgkmcnt(0)
    s_add_u32 s87, s87, 0x10000
    s_add_u32 s88, s87, 0x1000
L_go:
    v_lshlrev_b32 v14, 4, v2
    ds_read_b128 v[32:35], v14 offset:8832
    ds_read_b128 v[36:39], v14 offset:8896
    ds_read_b128 v[40:43], v14 offset:8960
    ds_read_b128 v[44:47], v14 offset:9024
    s_waitcnt lgkmcnt(0)
    v_mov_b32 v16, 0xff7fffff
    v_mov_b32 v17, 0
    v_mov_b32 v48, 0
    v_mov_b32 v49, 0
    v_mov_b32 v50, 0
    v_mov_b32 v51, 0
    v_mov_b32 v52, 0
    v_mov_b32 v53, 0
    v_mov_b32 v54, 0
    v_mov_b32 v55, 0
    v_mov_b32 v56, 0
    v_mov_b32 v57, 0
    v_mov_b32 v58, 0
    v_mov_b32 v59, 0
    v_mov_b32 v60, 0
    v_mov_b32 v61, 0
    v_mov_b32 v62, 0
    v_mov_b32 v63, 0
    v_mov_b32 v64, 0
    v_mov_b32 v65, 0
    v_mov_b32 v66, 0
    v_mov_b32 v67, 0
    v_mov_b32 v68, 0
    v_mov_b32 v69, 0
    v_mov_b32 v70, 0
    v_mov_b32 v71, 0
    v_mov_b32 v72, 0
    v_mov_b32 v73, 0
    v_mov_b32 v74, 0
    v_mov_b32 v75, 0
    v_mov_b32 v76, 0
    v_mov_b32 v77, 0
    v_mov_b32 v78, 0
    v_mov_b32 v79, 0
    s_mov_b32 s89, 0
    v_lshlrev_b32 v209, 2, v1
L_A:
    s_waitcnt vmcnt(8)
    v_mfma_f32_16x16x32_bf16 v[20:23], v[96:99], v[32:35], 0
    v_mfma_f32_16x16x32_bf16 v[24:27], v[112:115], v[32:35], 0
    v_mfma_f32_16x16x32_bf16 v[20:23], v[100:103], v[36:39], v[20:23]
    v_mfma_f32_16x16x32_bf16 v[24:27], v[116:119], v[36:39], v[24:27]
    v_mfma_f32_16x16x32_bf16 v[20:23], v[104:107], v[40:43], v[20:23]
    v_mfma_f32_16x16x32_bf16 v[24:27], v[120:123], v[40:43], v[24:27]
    v_mfma_f32_16x16x32_bf16 v[20:23], v[108:111], v[44:47], v[20:23]
    v_mfma_f32_16x16x32_bf16 v[24:27], v[124:127], v[44:47], v[24:27]
    s_cmp_eq_u32 s48, 1
    s_cbranch_scc1 L_sb1
    buffer_load_dwordx4 v[96:99], v4, s[4:7], s87 offen offset:0 nt
    buffer_load_dwordx4 v[100:103], v4, s[4:7], s87 offen offset:64 nt
    buffer_load_dwordx4 v[104:107], v4, s[4:7], s87 offen offset:128 nt
    buffer_load_dwordx4 v[108:111], v4, s[4:7], s87 offen offset:192 nt
    buffer_load_dwordx4 v[112:115], v4, s[4:7], s88 offen offset:0 nt
    buffer_load_dwordx4 v[116:119], v4, s[4:7], s88 offen offset:64 nt
    buffer_load_dwordx4 v[120:123], v4, s[4:7], s88 offen offset:128 nt
    buffer_load_dwordx4 v[124:127], v4, s[4:7], s88 offen offset:192 nt
    s_branch L_sd2
L_sb1:
    buffer_load_dwordx4 v[96:99], v4, s[12:15], s87 offen offset:0 nt
    buffer_load_dwordx4 v[100:103], v4, s[12:15], s87 offen offset:64 nt
    buffer_load_dwordx4 v[104:107], v4, s[12:15], s87 offen offset:128 nt
    buffer_load_dwordx4 v[108:111], v4, s[12:15], s87 offen offset:192 nt
    buffer_load_dwordx4 v[112:115], v4, s[12:15], s88 offen offset:0 nt
    buffer_load_dwordx4 v[116:119], v4, s[12:15], s88 offen offset:64 nt
    buffer_load_dwordx4 v[120:123], v4, s[12:15], s88 offen offset:128 nt
    buffer_load_dwordx4 v[124:127], v4, s[12:15], s88 offen offset:192 nt
L_sd2:
    v_cvt_pk_bf16_f32 v6, v20, v21
    v_lshlrev_b32 v20, 16, v6
    v_and_b32 v21, 0xffff0000, v6
    v_cvt_pk_bf16_f32 v7, v22, v23
    v_lshlrev_b32 v22, 16, v7
    v_and_b32 v23, 0xffff0000, v7
    v_cvt_pk_bf16_f32 v8, v24, v25
    v_lshlrev_b32 v24, 16, v8
    v_and_b32 v25, 0xffff0000, v8
    v_cvt_pk_bf16_f32 v9, v26, v27
    v_lshlrev_b32 v26, 16, v9
    v_and_b32 v27, 0xffff0000, v9
    v_mul_f32 v20, s85, v20
    v_mul_f32 v21, s85, v21
    v_mul_f32 v22, s85, v22
    v_mul_f32 v23, s85, v23
    v_mul_f32 v24, s85, v24
    v_mul_f32 v25, s85, v25
    v_mul_f32 v26, s85, v26
    v_mul_f32 v27, s85, v27
    v_cvt_pk_bf16_f32 v6, v20, v21
    v_lshlrev_b32 v20, 16, v6
    v_and_b32 v21, 0xffff0000, v6
    v_cvt_pk_bf16_f32 v7, v22, v23
    v_lshlrev_b32 v22, 16, v7
    v_and_b32 v23, 0xffff0000, v7
    v_cvt_pk_bf16_f32 v8, v24, v25
    v_lshlrev_b32 v24, 16, v8
    v_and_b32 v25, 0xffff0000, v8
    v_cvt_pk_bf16_f32 v9, v26, v27
    v_lshlrev_b32 v26, 16, v9
    v_and_b32 v27, 0xffff0000, v9
    v_max3_f32 v10, v20, v21, v22
    v_max3_f32 v11, v23, v24, v25
    v_max3_f32 v10, v10, v26, v27
    v_max3_f32 v10, v10, v11, v16
    v_mov_b32 v11, v10
    s_nop 1
    v_permlane32_swap_b32 v11, v10
    s_nop 0
    v_max_f32 v10, v11, v10
    v_mov_b32 v11, v10
    s_nop 1
    v_permlane16_swap_b32 v11, v10
    s_nop 0
    v_max_f32 v10, v11, v10
    v_sub_f32 v18, v16, v10
    v_mov_b32 v16, v10
    v_mul_f32 v18, s86, v18
    v_sub_f32 v20, v20, v16
    v_sub_f32 v21, v21, v16
    v_sub_f32 v22, v22, v16
    v_sub_f32 v23, v23, v16
    v_sub_f32 v24, v24, v16
    v_sub_f32 v25, v25, v16
    v_sub_f32 v26, v26, v16
    v_sub_f32 v27, v27, v16
    v_exp_f32 v18, v18
    v_mul_f32 v20, s86, v20
    v_mul_f32 v21, s86, v21
    v_mul_f32 v22, s86, v22
    v_mul_f32 v23, s86, v23
    v_mul_f32 v24, s86, v24
    v_mul_f32 v25, s86, v25
    v_mul_f32 v26, s86, v26
    v_mul_f32 v27, s86, v27
    v_exp_f32 v20, v20
    v_exp_f32 v21, v21
    v_exp_f32 v22, v22
    v_exp_f32 v23, v23
    v_exp_f32 v24, v24
    v_exp_f32 v25, v25
    v_exp_f32 v26, v26
    v_exp_f32 v27, v27
    v_pk_mul_f32 v[48:49], v[48:49], v[18:19] op_sel_hi:[1,0]
    v_pk_mul_f32 v[50:51], v[50:51], v[18:19] op_sel_hi:[1,0]
    v_pk_mul_f32 v[52:53], v[52:53], v[18:19] op_sel_hi:[1,0]
    v_pk_mul_f32 v[54:55], v[54:55], v[18:19] op_sel_hi:[1,0]
    v_pk_mul_f32 v[56:57], v[56:57], v[18:19] op_sel_hi:[1,0]
    v_pk_mul_f32 v[58:59], v[58:59], v[18:19] op_sel_hi:[1,0]
    v_pk_mul_f32 v[60:61], v[60:61], v[18:19] op_sel_hi:[1,0]
    v_pk_mul_f32 v[62:63], v[62:63], v[18:19] op_sel_hi:[1,0]
    v_pk_mul_f32 v[64:65], v[64:65], v[18:19] op_sel_hi:[1,0]
    v_pk_mul_f32 v[66:67], v[66:67], v[18:19] op_sel_hi:[1,0]
    v_pk_mul_f32 v[68:69], v[68:69], v[18:19] op_sel_hi:[1,0]
    v_pk_mul_f32 v[70:71], v[70:71], v[18:19] op_sel_hi:[1,0]
    v_pk_mul_f32 v[72:73], v[72:73], v[18:19] op_sel_hi:[1,0]
    v_pk_mul_f32 v[74:75], v[74:75], v[18:19] op_sel_hi:[1,0]
    v_pk_mul_f32 v[76:77], v[76:77], v[18:19] op_sel_hi:[1,0]
    v_pk_mul_f32 v[78:79], v[78:79], v[18:19] op_sel_hi:[1,0]
    v_cvt_pk_bf16_f32 v28, v20, v21
    v_cvt_pk_bf16_f32 v29, v22, v23
    v_cvt_pk_bf16_f32 v30, v24, v25
    v_cvt_pk_bf16_f32 v31, v26, v27
    v_add_f32 v6, v20, v21
    v_add_f32 v7, v22, v23
    v_add_f32 v8, v24, v25
    v_add_f32 v9, v26, v27
    v_add_f32 v6, v6, v7
    v_add_f32 v8, v8, v9
    v_add_f32 v6, v6, v8
    v_fma_f32 v17, v17, v18, v6
    s_waitcnt vmcnt(8)
    v_perm_b32 v80, v132, v128, s83
    v_perm_b32 v81, v140, v136, s83
    v_perm_b32 v82, v148, v144, s83
    v_perm_b32 v83, v156, v152, s83
    v_perm_b32 v84, v132, v128, s84
    v_perm_b32 v85, v140, v136, s84
    v_perm_b32 v86, v148, v144, s84
    v_perm_b32 v87, v156, v152, s84
    v_mfma_f32_16x16x32_bf16 v[48:51], v[80:83], v[28:31], v[48:51]
    v_perm_b32 v88, v133, v129, s83
    v_perm_b32 v89, v141, v137, s83
    v_perm_b32 v90, v149, v145, s83
    v_perm_b32 v91, v157, v153, s83
    v_mfma_f32_16x16x32_bf16 v[52:55], v[84:87], v[28:31], v[52:55]
    v_perm_b32 v92, v133, v129, s84
    v_perm_b32 v93, v141, v137, s84
    v_perm_b32 v94, v149, v145, s84
    v_perm_b32 v95, v157, v153, s84
    v_mfma_f32_16x16x32_bf16 v[56:59], v[88:91], v[28:31], v[56:59]
    v_perm_b32 v80, v134, v130, s83
    v_perm_b32 v81, v142, v138, s83
    v_perm_b32 v82, v150, v146, s83
    v_perm_b32 v83, v158, v154, s83
    v_mfma_f32_16x16x32_bf16 v[60:63], v[92:95], v[28:31], v[60:63]
    v_perm_b32 v84, v134, v130, s84
    v_perm_b32 v85, v142, v138, s84
    v_perm_b32 v86, v150, v146, s84
    v_perm_b32 v87, v158, v154, s84
    v_mfma_f32_16x16x32_bf16 v[64:67], v[80:83], v[28:31], v[64:67]
    v_perm_b32 v88, v135, v131, s83
    v_perm_b32 v89, v143, v139, s83
    v_perm_b32 v90, v151, v147, s83
    v_perm_b32 v91, v159, v155, s83
    v_mfma_f32_16x16x32_bf16 v[68:71], v[84:87], v[28:31], v[68:71]
    v_perm_b32 v92, v135, v131, s84
    v_perm_b32 v93, v143, v139, s84
    v_perm_b32 v94, v151, v147, s84
    v_perm_b32 v95, v159, v155, s84
    v_mfma_f32_16x16x32_bf16 v[72:75], v[88:91], v[28:31], v[72:75]
    s_nop 1
    v_mfma_f32_16x16x32_bf16 v[76:79], v[92:95], v[28:31], v[76:79]
    s_cmp_eq_u32 s48, 1
    s_cbranch_scc1 L_sb3
    buffer_load_dwordx4 v[128:131], v5, s[8:11], s87 offen offset:0 nt
    buffer_load_dwordx4 v[132:135], v5, s[8:11], s87 offen offset:1024 nt
    buffer_load_dwordx4 v[136:139], v5, s[8:11], s87 offen offset:2048 nt
    buffer_load_dwordx4 v[140:143], v5, s[8:11], s87 offen offset:3072 nt
    buffer_load_dwordx4 v[144:147], v5, s[8:11], s88 offen offset:0 nt
    buffer_load_dwordx4 v[148:151], v5, s[8:11], s88 offen offset:1024 nt
    buffer_load_dwordx4 v[152:155], v5, s[8:11], s88 offen offset:2048 nt
    buffer_load_dwordx4 v[156:159], v5, s[8:11], s88 offen offset:3072 nt
    s_branch L_sd4
L_sb3:
    buffer_load_dwordx4 v[128:131], v5, s[16:19], s87 offen offset:0 nt
    buffer_load_dwordx4 v[132:135], v5, s[16:19], s87 offen offset:1024 nt
    buffer_load_dwordx4 v[136:139], v5, s[16:19], s87 offen offset:2048 nt
    buffer_load_dwordx4 v[140:143], v5, s[16:19], s87 offen offset:3072 nt
    buffer_load_dwordx4 v[144:147], v5, s[16:19], s88 offen offset:0 nt
    buffer_load_dwordx4 v[148:151], v5, s[16:19], s88 offen offset:1024 nt
    buffer_load_dwordx4 v[152:155], v5, s[16:19], s88 offen offset:2048 nt
    buffer_load_dwordx4 v[156:159], v5, s[16:19], s88 offen offset:3072 nt
L_sd4:
    s_cmp_lt_u32 s89, 2
    s_cbranch_scc1 L_extra
    s_cmp_eq_u32 s48, 1
    s_cbranch_scc1 L_B
L_A2:
    s_cmp_eq_u32 s48, 2
    s_cbranch_scc1 L_last
L_A3:
    s_cmp_lg_u32 s49, 0
    s_cbranch_scc1 L_nb8
    v_mov_b32 v6, 0
    v_mov_b32 v7, 1
    s_mov_b64 exec, 1
    ds_read_b32 v8, v6 offset:11204
    s_mov_b64 exec, -1
    s_waitcnt lgkmcnt(0)
    v_readfirstlane_b32 s79, v8
    s_cmp_ge_u32 s79, 8
    s_cbranch_scc1 L_isb7
L_nb8:
    s_add_u32 s50, s50, 4
    s_mov_b32 s79, s50
    s_cmp_ge_u32 s79, s56
    s_cbranch_scc1 L_fin6
    s_mov_b32 s48, 0
    s_lshl_b32 s87, s79, 13
    s_branch L_dn5
L_fin6:
    s_cmp_lg_u32 s49, 0
    s_cbranch_scc1 L_f29
L_sp10:
    v_mov_b32 v6, 0
    v_mov_b32 v7, 1
    s_mov_b64 exec, 1
    ds_read_b32 v8, v6 offset:11204
    s_mov_b64 exec, -1
    s_waitcnt lgkmcnt(0)
    v_readfirstlane_b32 s79, v8
    s_cmp_ge_u32 s79, 8
    s_cbranch_scc1 L_isb7
    s_sub_u32 s90, s90, 1
    s_cbranch_scc1 L_isb7
    s_sleep 2
    s_branch L_sp10
L_isb7:
    s_mov_b32 s48, 1
    s_lshl_b32 s87, s78, 13
    s_branch L_dn5
L_f29:
    s_mov_b32 s48, 2
    s_add_u32 s79, s78, 120
    s_lshl_b32 s87, s79, 13
L_dn5:
    s_add_u32 s88, s87, 0x1000
    s_branch L_A
L_extra:
    s_cmp_eq_u32 s89, 0
    s_cbranch_scc1 L_E2
    s_cmp_eq_u32 s89, 1
    s_cbranch_scc1 L_E3
L_Eret:
    s_add_u32 s89, s89, 1
    s_add_u32 s87, s87, 0x10000
    s_add_u32 s88, s87, 0x1000
    s_branch L_A
L_E2:
    v_lshlrev_b32 v209, 2, v1
    buffer_load_dword v208, v209, s[64:67], 0 offen sc1
    v_lshlrev_b32 v10, 5, v1
    s_lshl_b32 s80, s78, 11
    buffer_load_dwordx4 v[176:179], v10, s[28:31], s80 offen
    buffer_load_dwordx4 v[180:183], v10, s[28:31], s80 offen offset:16
    buffer_load_dwordx4 v[184:187], v10, s[72:75], 0 offen
    buffer_load_dwordx4 v[188:191], v10, s[72:75], 0 offen offset:16
    s_branch L_Eret
L_E3:
    s_mov_b32 s79, 0x01010101
L_poll0:
    v_cmp_ne_u32 vcc, s79, v208
    s_cbranch_vccz L_poll0_done
    s_sub_u32 s90, s90, 1
    s_cbranch_scc1 L_poll0_done
    s_sleep 8
    buffer_load_dword v208, v209, s[64:67], 0 offen sc1
    s_waitcnt vmcnt(0)
    s_branch L_poll0
L_poll0_done:
    v_lshlrev_b32 v6, 16, v176
    v_lshlrev_b32 v7, 16, v184
    v_mul_f32 v192, v6, v7
    v_and_b32 v6, 0xffff0000, v176
    v_and_b32 v7, 0xffff0000, v184
    v_mul_f32 v193, v6, v7
    v_cvt_pk_bf16_f32 v8, v192, v193
    v_lshlrev_b32 v192, 16, v8
    v_and_b32 v193, 0xffff0000, v8
    v_add_f32 v192, v192, v193
    v_lshlrev_b32 v6, 16, v177
    v_lshlrev_b32 v7, 16, v185
    v_mul_f32 v194, v6, v7
    v_and_b32 v6, 0xffff0000, v177
    v_and_b32 v7, 0xffff0000, v185
    v_mul_f32 v195, v6, v7
    v_cvt_pk_bf16_f32 v8, v194, v195
    v_lshlrev_b32 v194, 16, v8
    v_and_b32 v195, 0xffff0000, v8
    v_add_f32 v194, v194, v195
    v_add_f32 v192, v192, v194
    v_lshlrev_b32 v6, 16, v178
    v_lshlrev_b32 v7, 16, v186
    v_mul_f32 v196, v6, v7
    v_and_b32 v6, 0xffff0000, v178
    v_and_b32 v7, 0xffff0000, v186
    v_mul_f32 v197, v6, v7
    v_cvt_pk_bf16_f32 v8, v196, v197
    v_lshlrev_b32 v196, 16, v8
    v_and_b32 v197, 0xffff0000, v8
    v_add_f32 v196, v196, v197
    v_add_f32 v192, v192, v196
    v_lshlrev_b32 v6, 16, v179
    v_lshlrev_b32 v7, 16, v187
    v_mul_f32 v198, v6, v7
    v_and_b32 v6, 0xffff0000, v179
    v_and_b32 v7, 0xffff0000, v187
    v_mul_f32 v199, v6, v7
    v_cvt_pk_bf16_f32 v8, v198, v199
    v_lshlrev_b32 v198, 16, v8
    v_and_b32 v199, 0xffff0000, v8
    v_add_f32 v198, v198, v199
    v_add_f32 v192, v192, v198
    v_lshlrev_b32 v6, 16, v180
    v_lshlrev_b32 v7, 16, v188
    v_mul_f32 v200, v6, v7
    v_and_b32 v6, 0xffff0000, v180
    v_and_b32 v7, 0xffff0000, v188
    v_mul_f32 v201, v6, v7
    v_cvt_pk_bf16_f32 v8, v200, v201
    v_lshlrev_b32 v200, 16, v8
    v_and_b32 v201, 0xffff0000, v8
    v_add_f32 v200, v200, v201
    v_add_f32 v192, v192, v200
    v_lshlrev_b32 v6, 16, v181
    v_lshlrev_b32 v7, 16, v189
    v_mul_f32 v202, v6, v7
    v_and_b32 v6, 0xffff0000, v181
    v_and_b32 v7, 0xffff0000, v189
    v_mul_f32 v203, v6, v7
    v_cvt_pk_bf16_f32 v8, v202, v203
    v_lshlrev_b32 v202, 16, v8
    v_and_b32 v203, 0xffff0000, v8
    v_add_f32 v202, v202, v203
    v_add_f32 v192, v192, v202
    v_lshlrev_b32 v6, 16, v182
    v_lshlrev_b32 v7, 16, v190
    v_mul_f32 v204, v6, v7
    v_and_b32 v6, 0xffff0000, v182
    v_and_b32 v7, 0xffff0000, v190
    v_mul_f32 v205, v6, v7
    v_cvt_pk_bf16_f32 v8, v204, v205
    v_lshlrev_b32 v204, 16, v8
    v_and_b32 v205, 0xffff0000, v8
    v_add_f32 v204, v204, v205
    v_add_f32 v192, v192, v204
    v_lshlrev_b32 v6, 16, v183
    v_lshlrev_b32 v7, 16, v191
    v_mul_f32 v206, v6, v7
    v_and_b32 v6, 0xffff0000, v183
    v_and_b32 v7, 0xffff0000, v191
    v_mul_f32 v207, v6, v7
    v_cvt_pk_bf16_f32 v8, v206, v207
    v_lshlrev_b32 v206, 16, v8
    v_and_b32 v207, 0xffff0000, v8
    v_add_f32 v206, v206, v207
    v_add_f32 v192, v192, v206
    s_nop 1
    v_add_f32_dpp v192, v192, v192 row_ror:8 row_mask:0xf bank_mask:0xf
    s_nop 1
    v_add_f32_dpp v192, v192, v192 row_ror:4 row_mask:0xf bank_mask:0xf
    s_nop 1
    v_add_f32_dpp v192, v192, v192 row_ror:2 row_mask:0xf bank_mask:0xf
    s_nop 1
    v_add_f32_dpp v192, v192, v192 row_ror:1 row_mask:0xf bank_mask:0xf
    v_mov_b32 v6, v192
    s_nop 1
    v_permlane32_swap_b32 v6, v192
    s_nop 0
    v_add_f32 v192, v6, v192
    v_mov_b32 v6, v192
    s_nop 1
    v_permlane16_swap_b32 v6, v192
    s_nop 0
    v_add_f32 v192, v6, v192
    v_cvt_pk_bf16_f32 v8, v192, v193
    v_lshlrev_b32 v192, 16, v8
    v_and_b32 v193, 0xffff0000, v8
    v_mul_f32 v192, s86, v192
    v_exp_f32 v192, -v192
    s_nop 0
    v_add_f32 v192, 1.0, v192
    v_rcp_f32 v192, v192
    s_nop 0
    v_cvt_pk_bf16_f32 v8, v192, v193
    v_lshlrev_b32 v192, 16, v8
    v_and_b32 v193, 0xffff0000, v8
    v_sub_f32 v193, 1.0, v192
    v_cvt_pk_bf16_f32 v8, v193, v194
    v_lshlrev_b32 v193, 16, v8
    v_and_b32 v194, 0xffff0000, v8
    s_lshl_b32 s79, s78, 3
    v_mov_b32 v6, s79
    ds_write_b64 v6, v[192:193] offset:11136
    s_add_u32 s89, s89, 1
    s_branch L_A3
L_B:
    s_mov_b32 s49, 1
    v_and_b32 v14, 7, v3
    v_lshlrev_b32 v14, 8, v14
    v_lshl_add_u32 v14, v2, 4, v14
    v_add_u32 v14, 256, v14
    v_mov_b32 v224, v48
    v_mov_b32 v225, v49
    v_mov_b32 v226, v50
    v_mov_b32 v227, v51
    v_mov_b32 v228, v52
    v_mov_b32 v229, v53
    v_mov_b32 v230, v54
    v_mov_b32 v231, v55
    v_mov_b32 v232, v56
    v_mov_b32 v233, v57
    v_mov_b32 v234, v58
    v_mov_b32 v235, v59
    v_mov_b32 v236, v60
    v_mov_b32 v237, v61
    v_mov_b32 v238, v62
    v_mov_b32 v239, v63
    v_mov_b32 v240, v64
    v_mov_b32 v241, v65
    v_mov_b32 v242, v66
    v_mov_b32 v243, v67
    v_mov_b32 v244, v68
    v_mov_b32 v245, v69
    v_mov_b32 v246, v70
    v_mov_b32 v247, v71
    v_mov_b32 v248, v72
    v_mov_b32 v249, v73
    v_mov_b32 v250, v74
    v_mov_b32 v251, v75
    v_mov_b32 v252, v76
    v_mov_b32 v253, v77
    v_mov_b32 v254, v78
    v_mov_b32 v255, v79
    v_mov_b32 v222, v16
    v_mov_b32 v223, v17
    ds_read_b128 v[32:35], v14 offset:8832
    ds_read_b128 v[36:39], v14 offset:8896
    ds_read_b128 v[40:43], v14 offset:8960
    ds_read_b128 v[44:47], v14 offset:9024
    s_waitcnt lgkmcnt(0)
    v_mov_b32 v16, 0xff7fffff
    v_mov_b32 v17, 0
    v_mov_b32 v48, 0
    v_mov_b32 v49, 0
    v_mov_b32 v50, 0
    v_mov_b32 v51, 0
    v_mov_b32 v52, 0
    v_mov_b32 v53, 0
    v_mov_b32 v54, 0
    v_mov_b32 v55, 0
    v_mov_b32 v56, 0
    v_mov_b32 v57, 0
    v_mov_b32 v58, 0
    v_mov_b32 v59, 0
    v_mov_b32 v60, 0
    v_mov_b32 v61, 0
    v_mov_b32 v62, 0
    v_mov_b32 v63, 0
    v_mov_b32 v64, 0
    v_mov_b32 v65, 0
    v_mov_b32 v66, 0
    v_mov_b32 v67, 0
    v_mov_b32 v68, 0
    v_mov_b32 v69, 0
    v_mov_b32 v70, 0
    v_mov_b32 v71, 0
    v_mov_b32 v72, 0
    v_mov_b32 v73, 0
    v_mov_b32 v74, 0
    v_mov_b32 v75, 0
    v_mov_b32 v76, 0
    v_mov_b32 v77, 0
    v_mov_b32 v78, 0
    v_mov_b32 v79, 0
    s_waitcnt vmcnt(8)
    v_mfma_f32_16x16x32_bf16 v[20:23], v[96:99], v[32:35], 0
    v_mfma_f32_16x16x32_bf16 v[24:27], v[112:115], v[32:35], 0
    v_mfma_f32_16x16x32_bf16 v[20:23], v[100:103], v[36:39], v[20:23]
    v_mfma_f32_16x16x32_bf16 v[24:27], v[116:119], v[36:39], v[24:27]
    v_mfma_f32_16x16x32_bf16 v[20:23], v[104:107], v[40:43], v[20:23]
    v_mfma_f32_16x16x32_bf16 v[24:27], v[120:123], v[40:43], v[24:27]
    v_mfma_f32_16x16x32_bf16 v[20:23], v[108:111], v[44:47], v[20:23]
    v_mfma_f32_16x16x32_bf16 v[24:27], v[124:127], v[44:47], v[24:27]
    s_add_u32 s87, s87, 0x10000
    s_add_u32 s88, s87, 0x1000
    buffer_load_dwordx4 v[96:99], v4, s[12:15], s87 offen offset:0 nt
    buffer_load_dwordx4 v[100:103], v4, s[12:15], s87 offen offset:64 nt
    buffer_load_dwordx4 v[104:107], v4, s[12:15], s87 offen offset:128 nt
    buffer_load_dwordx4 v[108:111], v4, s[12:15], s87 offen offset:192 nt
    buffer_load_dwordx4 v[112:115], v4, s[12:15], s88 offen offset:0 nt
    buffer_load_dwordx4 v[116:119], v4, s[12:15], s88 offen offset:64 nt
    buffer_load_dwordx4 v[120:123], v4, s[12:15], s88 offen offset:128 nt
    buffer_load_dwordx4 v[124:127], v4, s[12:15], s88 offen offset:192 nt
    v_cvt_pk_bf16_f32 v6, v20, v21
    v_lshlrev_b32 v20, 16, v6
    v_and_b32 v21, 0xffff0000, v6
    v_cvt_pk_bf16_f32 v7, v22, v23
    v_lshlrev_b32 v22, 16, v7
    v_and_b32 v23, 0xffff0000, v7
    v_cvt_pk_bf16_f32 v8, v24, v25
    v_lshlrev_b32 v24, 16, v8
    v_and_b32 v25, 0xffff0000, v8
    v_cvt_pk_bf16_f32 v9, v26, v27
    v_lshlrev_b32 v26, 16, v9
    v_and_b32 v27, 0xffff0000, v9
    v_mul_f32 v20, s85, v20
    v_mul_f32 v21, s85, v21
    v_mul_f32 v22, s85, v22
    v_mul_f32 v23, s85, v23
    v_mul_f32 v24, s85, v24
    v_mul_f32 v25, s85, v25
    v_mul_f32 v26, s85, v26
    v_mul_f32 v27, s85, v27
    v_cvt_pk_bf16_f32 v6, v20, v21
    v_lshlrev_b32 v20, 16, v6
    v_and_b32 v21, 0xffff0000, v6
    v_cvt_pk_bf16_f32 v7, v22, v23
    v_lshlrev_b32 v22, 16, v7
    v_and_b32 v23, 0xffff0000, v7
    v_cvt_pk_bf16_f32 v8, v24, v25
    v_lshlrev_b32 v24, 16, v8
    v_and_b32 v25, 0xffff0000, v8
    v_cvt_pk_bf16_f32 v9, v26, v27
    v_lshlrev_b32 v26, 16, v9
    v_and_b32 v27, 0xffff0000, v9
    v_max3_f32 v10, v20, v21, v22
    v_max3_f32 v11, v23, v24, v25
    v_max3_f32 v10, v10, v26, v27
    v_max3_f32 v10, v10, v11, v16
    v_mov_b32 v11, v10
    s_nop 1
    v_permlane32_swap_b32 v11, v10
    s_nop 0
    v_max_f32 v10, v11, v10
    v_mov_b32 v11, v10
    s_nop 1
    v_permlane16_swap_b32 v11, v10
    s_nop 0
    v_max_f32 v10, v11, v10
    v_sub_f32 v18, v16, v10
    v_mov_b32 v16, v10
    v_mul_f32 v18, s86, v18
    v_sub_f32 v20, v20, v16
    v_sub_f32 v21, v21, v16
    v_sub_f32 v22, v22, v16
    v_sub_f32 v23, v23, v16
    v_sub_f32 v24, v24, v16
    v_sub_f32 v25, v25, v16
    v_sub_f32 v26, v26, v16
    v_sub_f32 v27, v27, v16
    v_exp_f32 v18, v18
    v_mul_f32 v20, s86, v20
    v_mul_f32 v21, s86, v21
    v_mul_f32 v22, s86, v22
    v_mul_f32 v23, s86, v23
    v_mul_f32 v24, s86, v24
    v_mul_f32 v25, s86, v25
    v_mul_f32 v26, s86, v26
    v_mul_f32 v27, s86, v27
    v_exp_f32 v20, v20
    v_exp_f32 v21, v21
    v_exp_f32 v22, v22
    v_exp_f32 v23, v23
    v_exp_f32 v24, v24
    v_exp_f32 v25, v25
    v_exp_f32 v26, v26
    v_exp_f32 v27, v27
    v_pk_mul_f32 v[48:49], v[48:49], v[18:19] op_sel_hi:[1,0]
    v_pk_mul_f32 v[50:51], v[50:51], v[18:19] op_sel_hi:[1,0]
    v_pk_mul_f32 v[52:53], v[52:53], v[18:19] op_sel_hi:[1,0]
    v_pk_mul_f32 v[54:55], v[54:55], v[18:19] op_sel_hi:[1,0]
    v_pk_mul_f32 v[56:57], v[56:57], v[18:19] op_sel_hi:[1,0]
    v_pk_mul_f32 v[58:59], v[58:59], v[18:19] op_sel_hi:[1,0]
    v_pk_mul_f32 v[60:61], v[60:61], v[18:19] op_sel_hi:[1,0]
    v_pk_mul_f32 v[62:63], v[62:63], v[18:19] op_sel_hi:[1,0]
    v_pk_mul_f32 v[64:65], v[64:65], v[18:19] op_sel_hi:[1,0]
    v_pk_mul_f32 v[66:67], v[66:67], v[18:19] op_sel_hi:[1,0]
    v_pk_mul_f32 v[68:69], v[68:69], v[18:19] op_sel_hi:[1,0]
    v_pk_mul_f32 v[70:71], v[70:71], v[18:19] op_sel_hi:[1,0]
    v_pk_mul_f32 v[72:73], v[72:73], v[18:19] op_sel_hi:[1,0]
    v_pk_mul_f32 v[74:75], v[74:75], v[18:19] op_sel_hi:[1,0]
    v_pk_mul_f32 v[76:77], v[76:77], v[18:19] op_sel_hi:[1,0]
    v_pk_mul_f32 v[78:79], v[78:79], v[18:19] op_sel_hi:[1,0]
    v_cvt_pk_bf16_f32 v28, v20, v21
    v_cvt_pk_bf16_f32 v29, v22, v23
    v_cvt_pk_bf16_f32 v30, v24, v25
    v_cvt_pk_bf16_f32 v31, v26, v27
    v_add_f32 v6, v20, v21
    v_add_f32 v7, v22, v23
    v_add_f32 v8, v24, v25
    v_add_f32 v9, v26, v27
    v_add_f32 v6, v6, v7
    v_add_f32 v8, v8, v9
    v_add_f32 v6, v6, v8
    v_fma_f32 v17, v17, v18, v6
    s_waitcnt vmcnt(8)
    v_perm_b32 v80, v132, v128, s83
    v_perm_b32 v81, v140, v136, s83
    v_perm_b32 v82, v148, v144, s83
    v_perm_b32 v83, v156, v152, s83
    v_perm_b32 v84, v132, v128, s84
    v_perm_b32 v85, v140, v136, s84
    v_perm_b32 v86, v148, v144, s84
    v_perm_b32 v87, v156, v152, s84
    v_mfma_f32_16x16x32_bf16 v[48:51], v[80:83], v[28:31], v[48:51]
    v_perm_b32 v88, v133, v129, s83
    v_perm_b32 v89, v141, v137, s83
    v_perm_b32 v90, v149, v145, s83
    v_perm_b32 v91, v157, v153, s83
    v_mfma_f32_16x16x32_bf16 v[52:55], v[84:87], v[28:31], v[52:55]
    v_perm_b32 v92, v133, v129, s84
    v_perm_b32 v93, v141, v137, s84
    v_perm_b32 v94, v149, v145, s84
    v_perm_b32 v95, v157, v153, s84
    v_mfma_f32_16x16x32_bf16 v[56:59], v[88:91], v[28:31], v[56:59]
    v_perm_b32 v80, v134, v130, s83
    v_perm_b32 v81, v142, v138, s83
    v_perm_b32 v82, v150, v146, s83
    v_perm_b32 v83, v158, v154, s83
    v_mfma_f32_16x16x32_bf16 v[60:63], v[92:95], v[28:31], v[60:63]
    v_perm_b32 v84, v134, v130, s84
    v_perm_b32 v85, v142, v138, s84
    v_perm_b32 v86, v150, v146, s84
    v_perm_b32 v87, v158, v154, s84
    v_mfma_f32_16x16x32_bf16 v[64:67], v[80:83], v[28:31], v[64:67]
    v_perm_b32 v88, v135, v131, s83
    v_perm_b32 v89, v143, v139, s83
    v_perm_b32 v90, v151, v147, s83
    v_perm_b32 v91, v159, v155, s83
    v_mfma_f32_16x16x32_bf16 v[68:71], v[84:87], v[28:31], v[68:71]
    v_perm_b32 v92, v135, v131, s84
    v_perm_b32 v93, v143, v139, s84
    v_perm_b32 v94, v151, v147, s84
    v_perm_b32 v95, v159, v155, s84
    v_mfma_f32_16x16x32_bf16 v[72:75], v[88:91], v[28:31], v[72:75]
    s_nop 1
    v_mfma_f32_16x16x32_bf16 v[76:79], v[92:95], v[28:31], v[76:79]
    buffer_load_dwordx4 v[128:131], v5, s[16:19], s87 offen offset:0 nt
    buffer_load_dwordx4 v[132:135], v5, s[16:19], s87 offen offset:1024 nt
    buffer_load_dwordx4 v[136:139], v5, s[16:19], s87 offen offset:2048 nt
    buffer_load_dwordx4 v[140:143], v5, s[16:19], s87 offen offset:3072 nt
    buffer_load_dwordx4 v[144:147], v5, s[16:19], s88 offen offset:0 nt
    buffer_load_dwordx4 v[148:151], v5, s[16:19], s88 offen offset:1024 nt
    buffer_load_dwordx4 v[152:155], v5, s[16:19], s88 offen offset:2048 nt
    buffer_load_dwordx4 v[156:159], v5, s[16:19], s88 offen offset:3072 nt
    s_add_u32 s50, s50, 4
    s_mov_b32 s79, s50
    s_cmp_ge_u32 s79, s56
    s_cbranch_scc1 L_fin12
    s_mov_b32 s48, 0
    s_lshl_b32 s87, s79, 13
    s_branch L_dn11
L_fin12:
    s_mov_b32 s48, 2
    s_add_u32 s79, s78, 120
    s_lshl_b32 s87, s79, 13
L_dn11:
    s_add_u32 s88, s87, 0x1000
    s_waitcnt vmcnt(8)
    v_mfma_f32_16x16x32_bf16 v[20:23], v[96:99], v[32:35], 0
    v_mfma_f32_16x16x32_bf16 v[24:27], v[112:115], v[32:35], 0
    v_mfma_f32_16x16x32_bf16 v[20:23], v[100:103], v[36:39], v[20:23]
    v_mfma_f32_16x16x32_bf16 v[24:27], v[116:119], v[36:39], v[24:27]
    v_mfma_f32_16x16x32_bf16 v[20:23], v[104:107], v[40:43], v[20:23]
    v_mfma_f32_16x16x32_bf16 v[24:27], v[120:123], v[40:43], v[24:27]
    v_mfma_f32_16x16x32_bf16 v[20:23], v[108:111], v[44:47], v[20:23]
    v_mfma_f32_16x16x32_bf16 v[24:27], v[124:127], v[44:47], v[24:27]
    buffer_load_dwordx4 v[96:99], v4, s[4:7], s87 offen offset:0 nt
    buffer_load_dwordx4 v[100:103], v4, s[4:7], s87 offen offset:64 nt
    buffer_load_dwordx4 v[104:107], v4, s[4:7], s87 offen offset:128 nt
    buffer_load_dwordx4 v[108:111], v4, s[4:7], s87 offen offset:192 nt
    buffer_load_dwordx4 v[112:115], v4, s[4:7], s88 offen offset:0 nt
    buffer_load_dwordx4 v[116:119], v4, s[4:7], s88 offen offset:64 nt
    buffer_load_dwordx4 v[120:123], v4, s[4:7], s88 offen offset:128 nt
    buffer_load_dwordx4 v[124:127], v4, s[4:7], s88 offen offset:192 nt
    v_cvt_pk_bf16_f32 v6, v20, v21
    v_lshlrev_b32 v20, 16, v6
    v_and_b32 v21, 0xffff0000, v6
    v_cvt_pk_bf16_f32 v7, v22, v23
    v_lshlrev_b32 v22, 16, v7
    v_and_b32 v23, 0xffff0000, v7
    v_cvt_pk_bf16_f32 v8, v24, v25
    v_lshlrev_b32 v24, 16, v8
    v_and_b32 v25, 0xffff0000, v8
    v_cvt_pk_bf16_f32 v9, v26, v27
    v_lshlrev_b32 v26, 16, v9
    v_and_b32 v27, 0xffff0000, v9
    v_mul_f32 v20, s85, v20
    v_mul_f32 v21, s85, v21
    v_mul_f32 v22, s85, v22
    v_mul_f32 v23, s85, v23
    v_mul_f32 v24, s85, v24
    v_mul_f32 v25, s85, v25
    v_mul_f32 v26, s85, v26
    v_mul_f32 v27, s85, v27
    v_cvt_pk_bf16_f32 v6, v20, v21
    v_lshlrev_b32 v20, 16, v6
    v_and_b32 v21, 0xffff0000, v6
    v_cvt_pk_bf16_f32 v7, v22, v23
    v_lshlrev_b32 v22, 16, v7
    v_and_b32 v23, 0xffff0000, v7
    v_cvt_pk_bf16_f32 v8, v24, v25
    v_lshlrev_b32 v24, 16, v8
    v_and_b32 v25, 0xffff0000, v8
    v_cvt_pk_bf16_f32 v9, v26, v27
    v_lshlrev_b32 v26, 16, v9
    v_and_b32 v27, 0xffff0000, v9
    v_max3_f32 v10, v20, v21, v22
    v_max3_f32 v11, v23, v24, v25
    v_max3_f32 v10, v10, v26, v27
    v_max3_f32 v10, v10, v11, v16
    v_mov_b32 v11, v10
    s_nop 1
    v_permlane32_swap_b32 v11, v10
    s_nop 0
    v_max_f32 v10, v11, v10
    v_mov_b32 v11, v10
    s_nop 1
    v_permlane16_swap_b32 v11, v10
    s_nop 0
    v_max_f32 v10, v11, v10
    v_sub_f32 v18, v16, v10
    v_mov_b32 v16, v10
    v_mul_f32 v18, s86, v18
    v_sub_f32 v20, v20, v16
    v_sub_f32 v21, v21, v16
    v_sub_f32 v22, v22, v16
    v_sub_f32 v23, v23, v16
    v_sub_f32 v24, v24, v16
    v_sub_f32 v25, v25, v16
    v_sub_f32 v26, v26, v16
    v_sub_f32 v27, v27, v16
    v_exp_f32 v18, v18
    v_mul_f32 v20, s86, v20
    v_mul_f32 v21, s86, v21
    v_mul_f32 v22, s86, v22
    v_mul_f32 v23, s86, v23
    v_mul_f32 v24, s86, v24
    v_mul_f32 v25, s86, v25
    v_mul_f32 v26, s86, v26
    v_mul_f32 v27, s86, v27
    v_exp_f32 v20, v20
    v_exp_f32 v21, v21
    v_exp_f32 v22, v22
    v_exp_f32 v23, v23
    v_exp_f32 v24, v24
    v_exp_f32 v25, v25
    v_exp_f32 v26, v26
    v_exp_f32 v27, v27
    v_pk_mul_f32 v[48:49], v[48:49], v[18:19] op_sel_hi:[1,0]
    v_pk_mul_f32 v[50:51], v[50:51], v[18:19] op_sel_hi:[1,0]
    v_pk_mul_f32 v[52:53], v[52:53], v[18:19] op_sel_hi:[1,0]
    v_pk_mul_f32 v[54:55], v[54:55], v[18:19] op_sel_hi:[1,0]
    v_pk_mul_f32 v[56:57], v[56:57], v[18:19] op_sel_hi:[1,0]
    v_pk_mul_f32 v[58:59], v[58:59], v[18:19] op_sel_hi:[1,0]
    v_pk_mul_f32 v[60:61], v[60:61], v[18:19] op_sel_hi:[1,0]
    v_pk_mul_f32 v[62:63], v[62:63], v[18:19] op_sel_hi:[1,0]
    v_pk_mul_f32 v[64:65], v[64:65], v[18:19] op_sel_hi:[1,0]
    v_pk_mul_f32 v[66:67], v[66:67], v[18:19] op_sel_hi:[1,0]
    v_pk_mul_f32 v[68:69], v[68:69], v[18:19] op_sel_hi:[1,0]
    v_pk_mul_f32 v[70:71], v[70:71], v[18:19] op_sel_hi:[1,0]
    v_pk_mul_f32 v[72:73], v[72:73], v[18:19] op_sel_hi:[1,0]
    v_pk_mul_f32 v[74:75], v[74:75], v[18:19] op_sel_hi:[1,0]
    v_pk_mul_f32 v[76:77], v[76:77], v[18:19] op_sel_hi:[1,0]
    v_pk_mul_f32 v[78:79], v[78:79], v[18:19] op_sel_hi:[1,0]
    v_cvt_pk_bf16_f32 v28, v20, v21
    v_cvt_pk_bf16_f32 v29, v22, v23
    v_cvt_pk_bf16_f32 v30, v24, v25
    v_cvt_pk_bf16_f32 v31, v26, v27
    v_add_f32 v6, v20, v21
    v_add_f32 v7, v22, v23
    v_add_f32 v8, v24, v25
    v_add_f32 v9, v26, v27
    v_add_f32 v6, v6, v7
    v_add_f32 v8, v8, v9
    v_add_f32 v6, v6, v8
    v_fma_f32 v17, v17, v18, v6
    s_waitcnt vmcnt(8)
    v_perm_b32 v80, v132, v128, s83
    v_perm_b32 v81, v140, v136, s83
    v_perm_b32 v82, v148, v144, s83
    v_perm_b32 v83, v156, v152, s83
    v_perm_b32 v84, v132, v128, s84
    v_perm_b32 v85, v140, v136, s84
    v_perm_b32 v86, v148, v144, s84
    v_perm_b32 v87, v156, v152, s84
    v_mfma_f32_16x16x32_bf16 v[48:51], v[80:83], v[28:31], v[48:51]
    v_perm_b32 v88, v133, v129, s83
    v_perm_b32 v89, v141, v137, s83
    v_perm_b32 v90, v149, v145, s83
    v_perm_b32 v91, v157, v153, s83
    v_mfma_f32_16x16x32_bf16 v[52:55], v[84:87], v[28:31], v[52:55]
    v_perm_b32 v92, v133, v129, s84
    v_perm_b32 v93, v141, v137, s84
    v_perm_b32 v94, v149, v145, s84
    v_perm_b32 v95, v157, v153, s84
    v_mfma_f32_16x16x32_bf16 v[56:59], v[88:91], v[28:31], v[56:59]
    v_perm_b32 v80, v134, v130, s83
    v_perm_b32 v81, v142, v138, s83
    v_perm_b32 v82, v150, v146, s83
    v_perm_b32 v83, v158, v154, s83
    v_mfma_f32_16x16x32_bf16 v[60:63], v[92:95], v[28:31], v[60:63]
    v_perm_b32 v84, v134, v130, s84
    v_perm_b32 v85, v142, v138, s84
    v_perm_b32 v86, v150, v146, s84
    v_perm_b32 v87, v158, v154, s84
    v_mfma_f32_16x16x32_bf16 v[64:67], v[80:83], v[28:31], v[64:67]
    v_perm_b32 v88, v135, v131, s83
    v_perm_b32 v89, v143, v139, s83
    v_perm_b32 v90, v151, v147, s83
    v_perm_b32 v91, v159, v155, s83
    v_mfma_f32_16x16x32_bf16 v[68:71], v[84:87], v[28:31], v[68:71]
    v_perm_b32 v92, v135, v131, s84
    v_perm_b32 v93, v143, v139, s84
    v_perm_b32 v94, v151, v147, s84
    v_perm_b32 v95, v159, v155, s84
    v_mfma_f32_16x16x32_bf16 v[72:75], v[88:91], v[28:31], v[72:75]
    s_nop 1
    v_mfma_f32_16x16x32_bf16 v[76:79], v[92:95], v[28:31], v[76:79]
    buffer_load_dwordx4 v[128:131], v5, s[8:11], s87 offen offset:0 nt
    buffer_load_dwordx4 v[132:135], v5, s[8:11], s87 offen offset:1024 nt
    buffer_load_dwordx4 v[136:139], v5, s[8:11], s87 offen offset:2048 nt
    buffer_load_dwordx4 v[140:143], v5, s[8:11], s87 offen offset:3072 nt
    buffer_load_dwordx4 v[144:147], v5, s[8:11], s88 offen offset:0 nt
    buffer_load_dwordx4 v[148:151], v5, s[8:11], s88 offen offset:1024 nt
    buffer_load_dwordx4 v[152:155], v5, s[8:11], s88 offen offset:2048 nt
    buffer_load_dwordx4 v[156:159], v5, s[8:11], s88 offen offset:3072 nt
    v_mov_b32 v6, v17
    s_nop 1
    v_permlane32_swap_b32 v6, v17
    s_nop 0
    v_add_f32 v17, v6, v17
    v_mov_b32 v6, v17
    s_nop 1
    v_permlane16_swap_b32 v6, v17
    s_nop 0
    v_add_f32 v17, v6, v17
    s_lshl_b32 s79, s78, 6
    v_lshlrev_b32 v7, 3, v3
    v_add_u32 v7, s79, v7
    s_mov_b32 exec_lo, 0x00ff00ff
    s_mov_b32 exec_hi, 0x00ff00ff
    s_nop 1
    ds_write_b64 v7, v[16:17] offset:0
    ds_write_b128 v12, v[48:51] offset:15360
    ds_write_b128 v12, v[52:55] offset:15424
    ds_write_b128 v12, v[56:59] offset:15488
    ds_write_b128 v12, v[60:63] offset:15552
    ds_write_b128 v12, v[64:67] offset:15616
    ds_write_b128 v12, v[68:71] offset:15680
    ds_write_b128 v12, v[72:75] offset:15744
    ds_write_b128 v12, v[76:79] offset:15808
    s_mov_b64 exec, -1
    s_waitcnt lgkmcnt(0)
    v_mov_b32 v6, 0
    v_mov_b32 v7, 1
    s_mov_b64 exec, 1
    ds_add_rtn_u32 v8, v6, v7 offset:11208
    s_mov_b64 exec, -1
    s_waitcnt lgkmcnt(0)
    v_readfirstlane_b32 s79, v8
    s_cmp_lg_u32 s79, 7
    s_cbranch_scc1 L_Bdone
    v_lshlrev_b32 v8, 3, v1
    v_add_u32 v7, 15360, v8
    v_mov_b32 v9, 0
    v_mov_b32 v10, 0x7ffffff0
    v_cmp_eq_u32 vcc, 0, v1
    s_nop 1
    v_cndmask_b32 v10, v10, 0, vcc
    s_and_b32 s80, s91, 0xf8
    s_lshl_b32 s80, s80, 3
    s_and_b32 s81, s91, 7
    s_add_u32 s80, s80, s81
    s_lshl_b32 s79, s80, 9
    s_add_u32 s79, s79, 0x100000
    s_lshl_b32 s80, s80, 4
    s_add_u32 s80, s80, 0x200000
    s_mov_b32 s81, 8
L_Bc:
    ds_read_b64 v[162:163], v9 offset:0
    ds_read_b64 v[164:165], v9 offset:64
    ds_read_b64 v[166:167], v9 offset:128
    ds_read_b64 v[168:169], v9 offset:192
    ds_read_b64 v[170:171], v9 offset:256
    ds_read_b64 v[172:173], v9 offset:320
    ds_read_b64 v[174:175], v9 offset:384
    ds_read_b64 v[176:177], v9 offset:448
    ds_read_b64 v[178:179], v7 offset:0
    ds_read_b64 v[180:181], v7 offset:4224
    ds_read_b64 v[182:183], v7 offset:8448
    ds_read_b64 v[184:185], v7 offset:12672
    ds_read_b64 v[186:187], v7 offset:16896
    ds_read_b64 v[188:189], v7 offset:21120
    ds_read_b64 v[190:191], v7 offset:25344
    ds_read_b64 v[192:193], v7 offset:29568
    s_waitcnt lgkmcnt(8)
    v_max3_f32 v16, v162, v164, v166
    v_max3_f32 v16, v16, v168, v170
    v_max3_f32 v16, v16, v172, v174
    v_max_f32 v16, v16, v176
    v_sub_f32 v162, v162, v16
    v_sub_f32 v164, v164, v16
    v_sub_f32 v166, v166, v16
    v_sub_f32 v168, v168, v16
    v_sub_f32 v170, v170, v16
    v_sub_f32 v172, v172, v16
    v_sub_f32 v174, v174, v16
    v_sub_f32 v176, v176, v16
    v_mul_f32 v162, s86, v162
    v_mul_f32 v164, s86, v164
    v_mul_f32 v166, s86, v166
    v_mul_f32 v168, s86, v168
    v_mul_f32 v170, s86, v170
    v_mul_f32 v172, s86, v172
    v_mul_f32 v174, s86, v174
    v_mul_f32 v176, s86, v176
    v_exp_f32 v162, v162
    v_exp_f32 v164, v164
    v_exp_f32 v166, v166
    v_exp_f32 v168, v168
    v_exp_f32 v170, v170
    v_exp_f32 v172, v172
    v_exp_f32 v174, v174
    v_exp_f32 v176, v176
    s_waitcnt lgkmcnt(0)
    v_mul_f32 v17, v162, v163
    v_mul_f32 v160, v162, v178
    v_mul_f32 v161, v162, v179
    v_fmac_f32 v17, v164, v165
    v_fmac_f32 v160, v164, v180
    v_fmac_f32 v161, v164, v181
    v_fmac_f32 v17, v166, v167
    v_fmac_f32 v160, v166, v182
    v_fmac_f32 v161, v166, v183
    v_fmac_f32 v17, v168, v169
    v_fmac_f32 v160, v168, v184
    v_fmac_f32 v161, v168, v185
    v_fmac_f32 v17, v170, v171
    v_fmac_f32 v160, v170, v186
    v_fmac_f32 v161, v170, v187
    v_fmac_f32 v17, v172, v173
    v_fmac_f32 v160, v172, v188
    v_fmac_f32 v161, v172, v189
    v_fmac_f32 v17, v174, v175
    v_fmac_f32 v160, v174, v190
    v_fmac_f32 v161, v174, v191
    v_fmac_f32 v17, v176, v177
    v_fmac_f32 v160, v176, v192
    v_fmac_f32 v161, v176, v193
    buffer_store_dwordx2 v[160:161], v8, s[32:35], s79 offen sc1
    buffer_store_dwordx2 v[16:17], v10, s[32:35], s80 offen sc1
    v_add_u32 v7, 528, v7
    v_add_u32 v9, 8, v9
    s_add_u32 s79, s79, 0x1000
    s_add_u32 s80, s80, 0x80
    s_sub_u32 s81, s81, 1
    s_cmp_lg_u32 s81, 0
    s_cbranch_scc1 L_Bc
L_Bdone:
    v_lshlrev_b32 v14, 4, v2
    v_mov_b32 v48, v224
    v_mov_b32 v49, v225
    v_mov_b32 v50, v226
    v_mov_b32 v51, v227
    v_mov_b32 v52, v228
    v_mov_b32 v53, v229
    v_mov_b32 v54, v230
    v_mov_b32 v55, v231
    v_mov_b32 v56, v232
    v_mov_b32 v57, v233
    v_mov_b32 v58, v234
    v_mov_b32 v59, v235
    v_mov_b32 v60, v236
    v_mov_b32 v61, v237
    v_mov_b32 v62, v238
    v_mov_b32 v63, v239
    v_mov_b32 v64, v240
    v_mov_b32 v65, v241
    v_mov_b32 v66, v242
    v_mov_b32 v67, v243
    v_mov_b32 v68, v244
    v_mov_b32 v69, v245
    v_mov_b32 v70, v246
    v_mov_b32 v71, v247
    v_mov_b32 v72, v248
    v_mov_b32 v73, v249
    v_mov_b32 v74, v250
    v_mov_b32 v75, v251
    v_mov_b32 v76, v252
    v_mov_b32 v77, v253
    v_mov_b32 v78, v254
    v_mov_b32 v79, v255
    v_mov_b32 v16, v222
    v_mov_b32 v17, v223
    ds_read_b128 v[32:35], v14 offset:8832
    ds_read_b128 v[36:39], v14 offset:8896
    ds_read_b128 v[40:43], v14 offset:8960
    ds_read_b128 v[44:47], v14 offset:9024
    s_waitcnt lgkmcnt(0)
    s_branch L_A2
L_last:
    s_waitcnt vmcnt(8)
    v_mfma_f32_16x16x32_bf16 v[20:23], v[96:99], v[32:35], 0
    v_mfma_f32_16x16x32_bf16 v[24:27], v[112:115], v[32:35], 0
    v_mfma_f32_16x16x32_bf16 v[20:23], v[100:103], v[36:39], v[20:23]
    v_mfma_f32_16x16x32_bf16 v[24:27], v[116:119], v[36:39], v[24:27]
    v_mfma_f32_16x16x32_bf16 v[20:23], v[104:107], v[40:43], v[20:23]
    v_mfma_f32_16x16x32_bf16 v[24:27], v[120:123], v[40:43], v[24:27]
    v_mfma_f32_16x16x32_bf16 v[20:23], v[108:111], v[44:47], v[20:23]
    v_mfma_f32_16x16x32_bf16 v[24:27], v[124:127], v[44:47], v[24:27]
    s_lshl_b32 s79, s76, 7
    s_and_b32 s80, s78, 3
    s_lshl_b32 s80, s80, 5
    s_add_u32 s79, s79, s80
    s_lshl_b32 s79, s79, 11
    s_lshl_b32 s80, s77, 8
    s_add_u32 s79, s79, s80
    v_lshlrev_b32 v15, 14, v2
    v_lshl_add_u32 v15, v3, 4, v15
    s_lshl_b32 s81, s91, 3
    s_add_u32 s81, s81, s78
    s_lshl_b32 s82, s81, 4
    s_add_u32 s82, s82, 0x200000
    s_lshl_b32 s81, s81, 9
    s_add_u32 s81, s81, 0x100000
    v_lshlrev_b32 v204, 3, v1
    v_mov_b32 v205, 0
    buffer_load_dwordx2 v[200:201], v204, s[32:35], s81 offen sc1
    buffer_load_dwordx2 v[202:203], v205, s[32:35], s82 offen sc1
    buffer_load_dwordx4 v[96:99], v15, s[24:27], s79 offen offset:0 nt
    buffer_load_dwordx4 v[100:103], v15, s[24:27], s79 offen offset:2048 nt
    s_add_u32 s79, s79, 0x1000
    buffer_load_dwordx4 v[104:107], v15, s[24:27], s79 offen offset:0 nt
    buffer_load_dwordx4 v[108:111], v15, s[24:27], s79 offen offset:2048 nt
    s_add_u32 s79, s79, 0x1000
    buffer_load_dwordx4 v[112:115], v15, s[24:27], s79 offen offset:0 nt
    buffer_load_dwordx4 v[116:119], v15, s[24:27], s79 offen offset:2048 nt
    s_add_u32 s79, s79, 0x1000
    buffer_load_dwordx4 v[120:123], v15, s[24:27], s79 offen offset:0 nt
    buffer_load_dwordx4 v[124:127], v15, s[24:27], s79 offen offset:2048 nt
    v_cvt_pk_bf16_f32 v6, v20, v21
    v_lshlrev_b32 v20, 16, v6
    v_and_b32 v21, 0xffff0000, v6
    v_cvt_pk_bf16_f32 v7, v22, v23
    v_lshlrev_b32 v22, 16, v7
    v_and_b32 v23, 0xffff0000, v7
    v_cvt_pk_bf16_f32 v8, v24, v25
    v_lshlrev_b32 v24, 16, v8
    v_and_b32 v25, 0xffff0000, v8
    v_cvt_pk_bf16_f32 v9, v26, v27
    v_lshlrev_b32 v26, 16, v9
    v_and_b32 v27, 0xffff0000, v9
    v_mul_f32 v20, s85, v20
    v_mul_f32 v21, s85, v21
    v_mul_f32 v22, s85, v22
    v_mul_f32 v23, s85, v23
    v_mul_f32 v24, s85, v24
    v_mul_f32 v25, s85, v25
    v_mul_f32 v26, s85, v26
    v_mul_f32 v27, s85, v27
    v_cvt_pk_bf16_f32 v6, v20, v21
    v_lshlrev_b32 v20, 16, v6
    v_and_b32 v21, 0xffff0000, v6
    v_cvt_pk_bf16_f32 v7, v22, v23
    v_lshlrev_b32 v22, 16, v7
    v_and_b32 v23, 0xffff0000, v7
    v_cvt_pk_bf16_f32 v8, v24, v25
    v_lshlrev_b32 v24, 16, v8
    v_and_b32 v25, 0xffff0000, v8
    v_cvt_pk_bf16_f32 v9, v26, v27
    v_lshlrev_b32 v26, 16, v9
    v_and_b32 v27, 0xffff0000, v9
    v_max3_f32 v10, v20, v21, v22
    v_max3_f32 v11, v23, v24, v25
    v_max3_f32 v10, v10, v26, v27
    v_max3_f32 v10, v10, v11, v16
    v_mov_b32 v11, v10
    s_nop 1
    v_permlane32_swap_b32 v11, v10
    s_nop 0
    v_max_f32 v10, v11, v10
    v_mov_b32 v11, v10
    s_nop 1
    v_permlane16_swap_b32 v11, v10
    s_nop 0
    v_max_f32 v10, v11, v10
    v_sub_f32 v18, v16, v10
    v_mov_b32 v16, v10
    v_mul_f32 v18, s86, v18
    v_sub_f32 v20, v20, v16
    v_sub_f32 v21, v21, v16
    v_sub_f32 v22, v22, v16
    v_sub_f32 v23, v23, v16
    v_sub_f32 v24, v24, v16
    v_sub_f32 v25, v25, v16
    v_sub_f32 v26, v26, v16
    v_sub_f32 v27, v27, v16
    v_exp_f32 v18, v18
    v_mul_f32 v20, s86, v20
    v_mul_f32 v21, s86, v21
    v_mul_f32 v22, s86, v22
    v_mul_f32 v23, s86, v23
    v_mul_f32 v24, s86, v24
    v_mul_f32 v25, s86, v25
    v_mul_f32 v26, s86, v26
    v_mul_f32 v27, s86, v27
    v_exp_f32 v20, v20
    v_exp_f32 v21, v21
    v_exp_f32 v22, v22
    v_exp_f32 v23, v23
    v_exp_f32 v24, v24
    v_exp_f32 v25, v25
    v_exp_f32 v26, v26
    v_exp_f32 v27, v27
    v_pk_mul_f32 v[48:49], v[48:49], v[18:19] op_sel_hi:[1,0]
    v_pk_mul_f32 v[50:51], v[50:51], v[18:19] op_sel_hi:[1,0]
    v_pk_mul_f32 v[52:53], v[52:53], v[18:19] op_sel_hi:[1,0]
    v_pk_mul_f32 v[54:55], v[54:55], v[18:19] op_sel_hi:[1,0]
    v_pk_mul_f32 v[56:57], v[56:57], v[18:19] op_sel_hi:[1,0]
    v_pk_mul_f32 v[58:59], v[58:59], v[18:19] op_sel_hi:[1,0]
    v_pk_mul_f32 v[60:61], v[60:61], v[18:19] op_sel_hi:[1,0]
    v_pk_mul_f32 v[62:63], v[62:63], v[18:19] op_sel_hi:[1,0]
    v_pk_mul_f32 v[64:65], v[64:65], v[18:19] op_sel_hi:[1,0]
    v_pk_mul_f32 v[66:67], v[66:67], v[18:19] op_sel_hi:[1,0]
    v_pk_mul_f32 v[68:69], v[68:69], v[18:19] op_sel_hi:[1,0]
    v_pk_mul_f32 v[70:71], v[70:71], v[18:19] op_sel_hi:[1,0]
    v_pk_mul_f32 v[72:73], v[72:73], v[18:19] op_sel_hi:[1,0]
    v_pk_mul_f32 v[74:75], v[74:75], v[18:19] op_sel_hi:[1,0]
    v_pk_mul_f32 v[76:77], v[76:77], v[18:19] op_sel_hi:[1,0]
    v_pk_mul_f32 v[78:79], v[78:79], v[18:19] op_sel_hi:[1,0]
    v_cvt_pk_bf16_f32 v28, v20, v21
    v_cvt_pk_bf16_f32 v29, v22, v23
    v_cvt_pk_bf16_f32 v30, v24, v25
    v_cvt_pk_bf16_f32 v31, v26, v27
    v_add_f32 v6, v20, v21
    v_add_f32 v7, v22, v23
    v_add_f32 v8, v24, v25
    v_add_f32 v9, v26, v27
    v_add_f32 v6, v6, v7
    v_add_f32 v8, v8, v9
    v_add_f32 v6, v6, v8
    v_fma_f32 v17, v17, v18, v6
    s_waitcnt vmcnt(8)
    v_perm_b32 v80, v132, v128, s83
    v_perm_b32 v81, v140, v136, s83
    v_perm_b32 v82, v148, v144, s83
    v_perm_b32 v83, v156, v152, s83
    v_perm_b32 v84, v132, v128, s84
    v_perm_b32 v85, v140, v136, s84
    v_perm_b32 v86, v148, v144, s84
    v_perm_b32 v87, v156, v152, s84
    v_mfma_f32_16x16x32_bf16 v[48:51], v[80:83], v[28:31], v[48:51]
    v_perm_b32 v88, v133, v129, s83
    v_perm_b32 v89, v141, v137, s83
    v_perm_b32 v90, v149, v145, s83
    v_perm_b32 v91, v157, v153, s83
    v_mfma_f32_16x16x32_bf16 v[52:55], v[84:87], v[28:31], v[52:55]
    v_perm_b32 v92, v133, v129, s84
    v_perm_b32 v93, v141, v137, s84
    v_perm_b32 v94, v149, v145, s84
    v_perm_b32 v95, v157, v153, s84
    v_mfma_f32_16x16x32_bf16 v[56:59], v[88:91], v[28:31], v[56:59]
    v_perm_b32 v80, v134, v130, s83
    v_perm_b32 v81, v142, v138, s83
    v_perm_b32 v82, v150, v146, s83
    v_perm_b32 v83, v158, v154, s83
    v_mfma_f32_16x16x32_bf16 v[60:63], v[92:95], v[28:31], v[60:63]
    v_perm_b32 v84, v134, v130, s84
    v_perm_b32 v85, v142, v138, s84
    v_perm_b32 v86, v150, v146, s84
    v_perm_b32 v87, v158, v154, s84
    v_mfma_f32_16x16x32_bf16 v[64:67], v[80:83], v[28:31], v[64:67]
    v_perm_b32 v88, v135, v131, s83
    v_perm_b32 v89, v143, v139, s83
    v_perm_b32 v90, v151, v147, s83
    v_perm_b32 v91, v159, v155, s83
    v_mfma_f32_16x16x32_bf16 v[68:71], v[84:87], v[28:31], v[68:71]
    v_perm_b32 v92, v135, v131, s84
    v_perm_b32 v93, v143, v139, s84
    v_perm_b32 v94, v151, v147, s84
    v_perm_b32 v95, v159, v155, s84
    v_mfma_f32_16x16x32_bf16 v[72:75], v[88:91], v[28:31], v[72:75]
    s_nop 1
    v_mfma_f32_16x16x32_bf16 v[76:79], v[92:95], v[28:31], v[76:79]
L_pollB:
    v_cmp_eq_u32 vcc, -1, v200
    v_cmp_eq_u32 s[2:3], -1, v201
    s_or_b64 vcc, vcc, s[2:3]
    v_cmp_eq_u32 s[2:3], -1, v202
    s_or_b64 vcc, vcc, s[2:3]
    v_cmp_eq_u32 s[2:3], -1, v203
    s_or_b64 vcc, vcc, s[2:3]
    s_cbranch_scc0 L_pollB_done
    s_sub_u32 s90, s90, 1
    s_cbranch_scc1 L_pollB_done
    s_sleep 1
    buffer_load_dwordx2 v[200:201], v204, s[32:35], s81 offen sc1
    buffer_load_dwordx2 v[202:203], v205, s[32:35], s82 offen sc1
    s_waitcnt vmcnt(0)
    s_branch L_pollB
L_pollB_done:
    v_mov_b32 v6, v17
    s_nop 1
    v_permlane32_swap_b32 v6, v17
    s_nop 0
    v_add_f32 v17, v6, v17
    v_mov_b32 v6, v17
    s_nop 1
    v_permlane16_swap_b32 v6, v17
    s_nop 0
    v_add_f32 v17, v6, v17
    s_lshl_b32 s79, s78, 9
    v_lshl_add_u32 v7, v2, 4, s79
    v_add_u32 v8, s79, v204
    s_lshl_b32 s79, s78, 3
    v_mov_b32 v9, s79
    ds_write_b64 v8, v[200:201] offset:4672
    ds_write_b64 v9, v[202:203] offset:8768
    ds_write_b64 v9, v[16:17] offset:4608
    s_mov_b32 exec_lo, 0x00010001
    s_mov_b32 exec_hi, 0x00010001
    s_nop 1
    ds_write_b128 v7, v[48:51] offset:512
    ds_write_b128 v7, v[52:55] offset:576
    ds_write_b128 v7, v[56:59] offset:640
    ds_write_b128 v7, v[60:63] offset:704
    ds_write_b128 v7, v[64:67] offset:768
    ds_write_b128 v7, v[68:71] offset:832
    ds_write_b128 v7, v[72:75] offset:896
    ds_write_b128 v7, v[76:79] offset:960
    s_mov_b64 exec, -1
    v_and_b32 v10, 7, v3
    s_lshr_b32 s80, s78, 2
    s_lshl_b32 s79, s80, 2
    v_lshl_add_u32 v11, v10, 3, s79
    s_waitcnt lgkmcnt(0)
    s_barrier
L_tail:
    ds_read_b32 v19, v11 offset:11136
    s_cmp_gt_u32 s78, 1
    s_cbranch_scc1 L_nocomb
    s_mul_i32 s79, s78, 4160
    s_add_u32 s81, s79, 4608
    s_add_u32 s79, s79, 512
    v_and_b32 v7, 3, v1
    v_lshlrev_b32 v7, 7, v7
    v_lshrrev_b32 v8, 2, v1
    v_lshl_add_u32 v7, v8, 2, v7
    v_add_u32 v7, s79, v7
    v_mov_b32 v9, s81
    ds_read_b64 v[162:163], v9 offset:0
    ds_read_b64 v[164:165], v9 offset:8
    ds_read_b64 v[166:167], v9 offset:16
    ds_read_b64 v[168:169], v9 offset:24
    ds_read_b64 v[170:171], v9 offset:32
    ds_read_b64 v[172:173], v9 offset:40
    ds_read_b64 v[174:175], v9 offset:48
    ds_read_b64 v[176:177], v9 offset:56
    v_add_u32 v6, 0, v7
    ds_read2_b32 v[178:179], v6 offset0:0 offset1:16
    v_add_u32 v6, 512, v7
    ds_read2_b32 v[180:181], v6 offset0:0 offset1:16
    v_add_u32 v6, 1024, v7
    ds_read2_b32 v[182:183], v6 offset0:0 offset1:16
    v_add_u32 v6, 1536, v7
    ds_read2_b32 v[184:185], v6 offset0:0 offset1:16
    v_add_u32 v6, 2048, v7
    ds_read2_b32 v[186:187], v6 offset0:0 offset1:16
    v_add_u32 v6, 2560, v7
    ds_read2_b32 v[188:189], v6 offset0:0 offset1:16
    v_add_u32 v6, 3072, v7
    ds_read2_b32 v[190:191], v6 offset0:0 offset1:16
    v_add_u32 v6, 3584, v7
    ds_read2_b32 v[192:193], v6 offset0:0 offset1:16
    s_waitcnt lgkmcnt(8)
    v_max3_f32 v16, v162, v164, v166
    v_max3_f32 v16, v16, v168, v170
    v_max3_f32 v16, v16, v172, v174
    v_max_f32 v16, v16, v176
    v_sub_f32 v162, v162, v16
    v_sub_f32 v164, v164, v16
    v_sub_f32 v166, v166, v16
    v_sub_f32 v168, v168, v16
    v_sub_f32 v170, v170, v16
    v_sub_f32 v172, v172, v16
    v_sub_f32 v174, v174, v16
    v_sub_f32 v176, v176, v16
    v_mul_f32 v162, s86, v162
    v_mul_f32 v164, s86, v164
    v_mul_f32 v166, s86, v166
    v_mul_f32 v168, s86, v168
    v_mul_f32 v170, s86, v170
    v_mul_f32 v172, s86, v172
    v_mul_f32 v174, s86, v174
    v_mul_f32 v176, s86, v176
    v_exp_f32 v162, v162
    v_exp_f32 v164, v164
    v_exp_f32 v166, v166
    v_exp_f32 v168, v168
    v_exp_f32 v170, v170
    v_exp_f32 v172, v172
    v_exp_f32 v174, v174
    v_exp_f32 v176, v176
    s_waitcnt lgkmcnt(0)
    v_mul_f32 v17, v162, v163
    v_mul_f32 v160, v162, v178
    v_mul_f32 v161, v162, v179
    v_fmac_f32 v17, v164, v165
    v_fmac_f32 v160, v164, v180
    v_fmac_f32 v161, v164, v181
    v_fmac_f32 v17, v166, v167
    v_fmac_f32 v160, v166, v182
    v_fmac_f32 v161, v166, v183
    v_fmac_f32 v17, v168, v169
    v_fmac_f32 v160, v168, v184
    v_fmac_f32 v161, v168, v185
    v_fmac_f32 v17, v170, v171
    v_fmac_f32 v160, v170, v186
    v_fmac_f32 v161, v170, v187
    v_fmac_f32 v17, v172, v173
    v_fmac_f32 v160, v172, v188
    v_fmac_f32 v161, v172, v189
    v_fmac_f32 v17, v174, v175
    v_fmac_f32 v160, v174, v190
    v_fmac_f32 v161, v174, v191
    v_fmac_f32 v17, v176, v177
    v_fmac_f32 v160, v176, v192
    v_fmac_f32 v161, v176, v193
    v_rcp_f32 v17, v17
    s_nop 0
    v_mul_f32 v160, v160, v17
    v_mul_f32 v161, v161, v17
    v_cvt_pk_bf16_f32 v160, v160, v161
    s_lshl_b32 s79, s76, 1
    s_add_u32 s79, s79, s78
    s_lshl_b32 s79, s79, 3
    s_add_u32 s79, s79, s77
    s_lshl_b32 s79, s79, 8
    s_add_u32 s79, s79, 0x210000
    v_lshlrev_b32 v8, 2, v1
    buffer_store_dword v160, v8, s[32:35], s79 offen sc1
L_nocomb:
    s_lshr_b32 s80, s78, 2
    s_lshl_b32 s79, s76, 1
    s_add_u32 s79, s79, s80
    s_lshl_b32 s79, s79, 11
    s_and_b32 s80, s78, 3
    s_lshl_b32 s80, s80, 6
    s_add_u32 s79, s79, s80
    s_add_u32 s79, s79, 0x210000
    v_lshlrev_b32 v10, 8, v10
    v_lshl_add_u32 v10, v2, 4, v10
L_pollO:
    buffer_load_dwordx4 v[28:31], v10, s[32:35], s79 offen sc1
    s_waitcnt vmcnt(0)
    v_max3_u32 v6, v28, v29, v30
    v_max_u32 v6, v6, v31
    v_cmp_eq_u32 vcc, -1, v6
    s_cbranch_vccz L_pollO_done
    s_sub_u32 s90, s90, 1
    s_cbranch_scc1 L_pollO_done
    s_sleep 1
    s_branch L_pollO
L_pollO_done:
    s_waitcnt lgkmcnt(0)
    v_mov_b32 v18, v19
    v_perm_b32 v80, v100, v96, s83
    v_perm_b32 v81, v108, v104, s83
    v_perm_b32 v82, v116, v112, s83
    v_perm_b32 v83, v124, v120, s83
    v_perm_b32 v84, v100, v96, s84
    v_perm_b32 v85, v108, v104, s84
    v_perm_b32 v86, v116, v112, s84
    v_perm_b32 v87, v124, v120, s84
    v_mfma_f32_16x16x32_bf16 v[48:51], v[80:83], v[28:31], 0
    v_perm_b32 v88, v101, v97, s83
    v_perm_b32 v89, v109, v105, s83
    v_perm_b32 v90, v117, v113, s83
    v_perm_b32 v91, v125, v121, s83
    v_mfma_f32_16x16x32_bf16 v[52:55], v[84:87], v[28:31], 0
    v_perm_b32 v92, v101, v97, s84
    v_perm_b32 v93, v109, v105, s84
    v_perm_b32 v94, v117, v113, s84
    v_perm_b32 v95, v125, v121, s84
    v_mfma_f32_16x16x32_bf16 v[56:59], v[88:91], v[28:31], 0
    v_perm_b32 v80, v102, v98, s83
    v_perm_b32 v81, v110, v106, s83
    v_perm_b32 v82, v118, v114, s83
    v_perm_b32 v83, v126, v122, s83
    v_mfma_f32_16x16x32_bf16 v[60:63], v[92:95], v[28:31], 0
    v_perm_b32 v84, v102, v98, s84
    v_perm_b32 v85, v110, v106, s84
    v_perm_b32 v86, v118, v114, s84
    v_perm_b32 v87, v126, v122, s84
    v_mfma_f32_16x16x32_bf16 v[64:67], v[80:83], v[28:31], 0
    v_perm_b32 v88, v103, v99, s83
    v_perm_b32 v89, v111, v107, s83
    v_perm_b32 v90, v119, v115, s83
    v_perm_b32 v91, v127, v123, s83
    v_mfma_f32_16x16x32_bf16 v[68:71], v[84:87], v[28:31], 0
    v_perm_b32 v92, v103, v99, s84
    v_perm_b32 v93, v111, v107, s84
    v_perm_b32 v94, v119, v115, s84
    v_perm_b32 v95, v127, v123, s84
    v_mfma_f32_16x16x32_bf16 v[72:75], v[88:91], v[28:31], 0
    s_nop 1
    v_mfma_f32_16x16x32_bf16 v[76:79], v[92:95], v[28:31], 0
    s_nop 7
    v_pk_mul_f32 v[48:49], v[48:49], v[18:19] op_sel_hi:[1,0]
    v_pk_mul_f32 v[50:51], v[50:51], v[18:19] op_sel_hi:[1,0]
    v_pk_mul_f32 v[52:53], v[52:53], v[18:19] op_sel_hi:[1,0]
    v_pk_mul_f32 v[54:55], v[54:55], v[18:19] op_sel_hi:[1,0]
    v_pk_mul_f32 v[56:57], v[56:57], v[18:19] op_sel_hi:[1,0]
    v_pk_mul_f32 v[58:59], v[58:59], v[18:19] op_sel_hi:[1,0]
    v_pk_mul_f32 v[60:61], v[60:61], v[18:19] op_sel_hi:[1,0]
    v_pk_mul_f32 v[62:63], v[62:63], v[18:19] op_sel_hi:[1,0]
    v_pk_mul_f32 v[64:65], v[64:65], v[18:19] op_sel_hi:[1,0]
    v_pk_mul_f32 v[66:67], v[66:67], v[18:19] op_sel_hi:[1,0]
    v_pk_mul_f32 v[68:69], v[68:69], v[18:19] op_sel_hi:[1,0]
    v_pk_mul_f32 v[70:71], v[70:71], v[18:19] op_sel_hi:[1,0]
    v_pk_mul_f32 v[72:73], v[72:73], v[18:19] op_sel_hi:[1,0]
    v_pk_mul_f32 v[74:75], v[74:75], v[18:19] op_sel_hi:[1,0]
    v_pk_mul_f32 v[76:77], v[76:77], v[18:19] op_sel_hi:[1,0]
    v_pk_mul_f32 v[78:79], v[78:79], v[18:19] op_sel_hi:[1,0]
    s_mov_b32 exec_lo, 0x00ff00ff
    s_mov_b32 exec_hi, 0x00ff00ff
    s_nop 1
    ds_write_b128 v12, v[48:51] offset:15360
    ds_write_b128 v12, v[52:55] offset:15424
    ds_write_b128 v12, v[56:59] offset:15488
    ds_write_b128 v12, v[60:63] offset:15552
    ds_write_b128 v12, v[64:67] offset:15616
    ds_write_b128 v12, v[68:71] offset:15680
    ds_write_b128 v12, v[72:75] offset:15744
    ds_write_b128 v12, v[76:79] offset:15808
    s_mov_b64 exec, -1
    s_mul_i32 s79, s78, 528
    s_add_u32 s79, s79, 15360
    v_and_b32 v7, 3, v1
    v_lshlrev_b32 v7, 7, v7
    v_lshrrev_b32 v8, 2, v1
    v_lshl_add_u32 v7, v8, 2, v7
    v_add_u32 v7, s79, v7
    v_add_u32 v177, 4224, v7
    v_add_u32 v178, 8448, v7
    v_add_u32 v179, 12672, v7
    v_add_u32 v180, 16896, v7
    v_add_u32 v181, 21120, v7
    v_add_u32 v182, 25344, v7
    v_add_u32 v183, 29568, v7
    s_waitcnt lgkmcnt(0)
    s_barrier
L_nb2:
    ds_read2_b32 v[160:161], v7 offset0:0 offset1:16
    ds_read2_b32 v[162:163], v177 offset0:0 offset1:16
    ds_read2_b32 v[164:165], v178 offset0:0 offset1:16
    ds_read2_b32 v[166:167], v179 offset0:0 offset1:16
    ds_read2_b32 v[168:169], v180 offset0:0 offset1:16
    ds_read2_b32 v[170:171], v181 offset0:0 offset1:16
    ds_read2_b32 v[172:173], v182 offset0:0 offset1:16
    ds_read2_b32 v[174:175], v183 offset0:0 offset1:16
    s_lshl_b32 s79, s91, 3
    s_add_u32 s79, s79, s78
    s_lshl_b32 s79, s79, 9
    s_add_u32 s79, s79, 0x300000
    s_waitcnt lgkmcnt(0)
    v_add_f32 v160, v160, v168
    v_add_f32 v161, v161, v169
    v_add_f32 v162, v162, v170
    v_add_f32 v163, v163, v171
    v_add_f32 v164, v164, v172
    v_add_f32 v165, v165, v173
    v_add_f32 v166, v166, v174
    v_add_f32 v167, v167, v175
    v_add_f32 v160, v160, v164
    v_add_f32 v161, v161, v165
    v_add_f32 v162, v162, v166
    v_add_f32 v163, v163, v167
    v_add_f32 v160, v160, v162
    v_add_f32 v161, v161, v163
    buffer_store_dwordx2 v[160:161], v204, s[32:35], s79 offen sc1
    s_cmp_lg_u32 s78, 0
    s_cbranch_scc1 L_end
    s_lshl_b32 s79, s77, 17
    s_lshl_b32 s80, s76, 7
    s_add_u32 s79, s79, s80
    s_add_u32 s79, s79, 0x300000
    s_add_u32 s80, s79, 0x8000
    s_add_u32 s81, s79, 0x10000
    s_add_u32 s82, s79, 0x18000
    v_lshrrev_b32 v7, 3, v1
    v_lshlrev_b32 v7, 12, v7
    v_and_b32 v8, 7, v1
    v_lshl_add_u32 v7, v8, 4, v7
L_pollP:
    buffer_load_dwordx4 v[160:163], v7, s[32:35], s79 offen sc1
    buffer_load_dwordx4 v[164:167], v7, s[32:35], s80 offen sc1
    buffer_load_dwordx4 v[168:171], v7, s[32:35], s81 offen sc1
    buffer_load_dwordx4 v[172:175], v7, s[32:35], s82 offen sc1
    s_waitcnt vmcnt(0)
    v_max3_u32 v6, v160, v161, v162
    v_max3_u32 v6, v6, v163, v164
    v_max3_u32 v6, v6, v165, v166
    v_max3_u32 v6, v6, v167, v168
    v_max3_u32 v6, v6, v169, v170
    v_max3_u32 v6, v6, v171, v172
    v_max3_u32 v6, v6, v173, v174
    v_max_u32 v6, v6, v175
    v_cmp_eq_u32 vcc, -1, v6
    s_cbranch_vccz L_pollP_done
    s_sub_u32 s90, s90, 1
    s_cbranch_scc1 L_pollP_done
    s_sleep 1
    s_branch L_pollP
L_pollP_done:
    v_add_f32 v160, v160, v168
    v_add_f32 v161, v161, v169
    v_add_f32 v162, v162, v170
    v_add_f32 v163, v163, v171
    v_add_f32 v164, v164, v172
    v_add_f32 v165, v165, v173
    v_add_f32 v166, v166, v174
    v_add_f32 v167, v167, v175
    v_add_f32 v160, v160, v164
    v_add_f32 v161, v161, v165
    v_add_f32 v162, v162, v166
    v_add_f32 v163, v163, v167
    s_nop 1
    v_add_f32_dpp v160, v160, v160 row_ror:8 row_mask:0xf bank_mask:0xf
    v_add_f32_dpp v161, v161, v161 row_ror:8 row_mask:0xf bank_mask:0xf
    v_add_f32_dpp v162, v162, v162 row_ror:8 row_mask:0xf bank_mask:0xf
    v_add_f32_dpp v163, v163, v163 row_ror:8 row_mask:0xf bank_mask:0xf
    v_mov_b32 v164, v160
    v_mov_b32 v165, v161
    v_mov_b32 v166, v162
    v_mov_b32 v167, v163
    s_nop 0
    v_permlane32_swap_b32 v164, v160
    v_permlane32_swap_b32 v165, v161
    v_permlane32_swap_b32 v166, v162
    v_permlane32_swap_b32 v167, v163
    s_nop 0
    v_add_f32 v160, v160, v164
    v_add_f32 v161, v161, v165
    v_add_f32 v162, v162, v166
    v_add_f32 v163, v163, v167
    v_mov_b32 v164, v160
    v_mov_b32 v165, v161
    v_mov_b32 v166, v162
    v_mov_b32 v167, v163
    s_nop 0
    v_permlane16_swap_b32 v164, v160
    v_permlane16_swap_b32 v165, v161
    v_permlane16_swap_b32 v166, v162
    v_permlane16_swap_b32 v167, v163
    s_nop 0
    v_add_f32 v160, v160, v164
    v_add_f32 v161, v161, v165
    v_add_f32 v162, v162, v166
    v_add_f32 v163, v163, v167
    v_cvt_pk_bf16_f32 v160, v160, v161
    v_cvt_pk_bf16_f32 v161, v162, v163
    s_lshr_b32 s79, s76, 2
    s_lshl_b32 s79, s79, 11
    s_lshl_b32 s80, s77, 8
    s_add_u32 s79, s79, s80
    s_and_b32 s80, s76, 3
    s_lshl_b32 s80, s80, 6
    s_add_u32 s79, s79, s80
    v_mov_b32 v9, 0x7ffffff0
    v_cmp_gt_u32 vcc, 8, v1
    s_nop 1
    v_cndmask_b32 v9, v9, v204, vcc
    buffer_store_dwordx2 v[160:161], v9, s[68:71], s79 offen
    s_cmp_lg_u32 s91, 0
    s_cbranch_scc1 L_nobump
    s_add_u32 s52, s52, 0x01000193
    v_mov_b32 v6, s52
    v_mov_b32 v7, 0x280000
    buffer_store_dword v6, v7, s[32:35], 0 offen
L_nobump:
L_end:
s_endpgm
.section .rodata,"a"
.p2align 6
.amdhsa_kernel gated_mix__mha_block_cached__gqa_block_cached__decode_kernel
  .amdhsa_next_free_vgpr 256
  .amdhsa_next_free_sgpr 102
  .amdhsa_accum_offset 256
  .amdhsa_group_segment_fixed_size 0
  .amdhsa_kernarg_size 112
  .amdhsa_user_sgpr_count 2
  .amdhsa_user_sgpr_kernarg_segment_ptr 1
  .amdhsa_system_sgpr_workgroup_id_x 1
.end_amdhsa_kernel
```
